```python
import torch

def _softmax(x, axis=-1):
    return torch.softmax(x, dim=axis)
def _gelu(x):
    return torch.nn.functional.gelu(x, approximate="tanh")
def _silu(x):
    return torch.nn.functional.silu(x)
def _sigmoid(x):
    return torch.sigmoid(x)
def _layernorm(x, axis=-1, eps=1e-5):
    m = x.mean(dim=axis, keepdim=True)
    v = x.var(dim=axis, keepdim=True, unbiased=False)
    return (x - m) / torch.sqrt(v + eps)
def _scatter_add(tgt, idx, src, axis=0):
    return tgt.clone().index_add_(axis, idx, src)
def _segment_sum(src, seg, n):
    out = torch.zeros((n,) + src.shape[1:], dtype=src.dtype)
    return out.index_add_(0, seg, src)
def _pad(x, pw):
    flat = tuple(v for pair in reversed(pw) for v in pair)
    return torch.nn.functional.pad(x, flat)

kernel_name = 'gated_mix__linear_kernel_hedgehog__mha_block__prompt'

def setup_inputs():

    _w = (lambda a: (lambda t: t.to(torch.bfloat16) if t.is_floating_point() else t)(torch.as_tensor(a)))
    def _A_setup():
        B, S, D, H = 1, 2048, 512, 32
        Dh = D // H
        return {
            "x": _w((lambda *s: torch.randn(*s, dtype=torch.bfloat16) * 0.05)(B, S, D)),
            "wqkv": _w((lambda *s: torch.randn(*s, dtype=torch.bfloat16) * 3.2)(D, 3 * D)),
            "w_phi": _w((lambda *s: torch.randn(*s, dtype=torch.bfloat16) * 3.2)(H, Dh, Dh) * (Dh ** -0.5)),
            "wo": _w((lambda *s: torch.randn(*s, dtype=torch.bfloat16) * 0.05)(D, D)),
        }
    _A_in = _A_setup()

    def _B_setup():
        B, S, D, H = 1, 2048, 512, 32
        return {
            "x": _w((lambda *s: torch.randn(*s, dtype=torch.bfloat16) * 0.05)(B, S, D)),
            "wqkv": _w((lambda *s: torch.randn(*s, dtype=torch.bfloat16) * 1.6)(D, 3 * D)),
            "wo": _w((lambda *s: torch.randn(*s, dtype=torch.bfloat16) * 0.05)(D, D)),
        }
    _B_in = _B_setup()

    return {
        "A_x": _A_in["x"],
        "A_wqkv": _A_in["wqkv"],
        "A_w_phi": _A_in["w_phi"],
        "A_wo": _A_in["wo"],
        "B_x": _B_in["x"],
        "B_wqkv": _B_in["wqkv"],
        "B_wo": _B_in["wo"],
        "gate_w": _w((lambda *s: torch.randn(*s, dtype=torch.bfloat16) * 0.05)(512) * 16.0),
    }

def reference(A_x, A_wqkv, A_w_phi, A_wo, B_x, B_wqkv, B_wo, gate_w):
    def _A_ref(x, wqkv, w_phi, wo):
        B, S, D = x.shape
        H = 32; Dh = D // H
        qkv = (lambda x, *d: x.permute(*d))((x @ wqkv).reshape(B, S, 3, H, Dh), 2, 0, 3, 1, 4)
        q, k, v = qkv[0], qkv[1], qkv[2]
        pq = torch.einsum("bhsd,hdf->bhsf", q, w_phi)
        pk = torch.einsum("bhsd,hdf->bhsf", k, w_phi)
        phi_q = torch.concatenate([_softmax(pq, axis=-1), _softmax(-pq, axis=-1)], axis=-1)
        phi_k = torch.concatenate([_softmax(pk, axis=-1), _softmax(-pk, axis=-1)], axis=-1)
        kv = torch.einsum("bhsf,bhsd->bhfd", phi_k, v)
        z  = torch.einsum("bhsf->bhf", phi_k)
        num = torch.einsum("bhqf,bhfd->bhqd", phi_q, kv)
        den = torch.einsum("bhqf,bhf->bhq", phi_q, z)[..., None] + 1e-6
        o = num / den
        return (lambda x, *d: x.permute(*d))(o, 0, 2, 1, 3).reshape(B, S, D) @ wo

    def _B_ref(x, wqkv, wo):
        B, S, D = x.shape
        H = 32
        Dh = D // H
        qkv = (lambda x, *d: x.permute(*d))((x @ wqkv).reshape(B, S, 3, H, Dh), 2, 0, 3, 1, 4)
        q, k, v = qkv[0], qkv[1], qkv[2]
        scores = torch.einsum("bhqd,bhkd->bhqk", q, k) * (Dh ** -0.5)
        p = _softmax(scores, axis=-1)
        o = torch.einsum("bhqk,bhkd->bhqd", p, v)
        return (lambda x, *d: x.permute(*d))(o, 0, 2, 1, 3).reshape(B, S, D) @ wo

    x = A_x
    g = _sigmoid((x * gate_w).sum(-1, keepdims=True))
    a = _A_ref(x, A_wqkv, A_w_phi, A_wo)
    b = _B_ref(x, B_wqkv, B_wo)
    return g * a + (1 - g) * b
```

```asm
; @launch grid=(256,1,1) block=(512,1,1) lds=163840
.amdgcn_target "amdgcn-amd-amdhsa--gfx950"
.text
.globl gated_mix__linear_kernel_hedgehog__mha_block__prompt_kernel
.p2align 8
.type gated_mix__linear_kernel_hedgehog__mha_block__prompt_kernel,@function
gated_mix__linear_kernel_hedgehog__mha_block__prompt_kernel:
    s_cmp_ge_u32 s2, 256
    s_cbranch_scc1 L_end
    s_load_dwordx4 s[4:7], s[0:1], 0
    s_load_dwordx2 s[10:11], s[0:1], 40
    s_load_dwordx2 s[32:33], s[0:1], 80
    s_load_dwordx2 s[8:9], s[0:1], 16
    s_load_dwordx2 s[12:13], s[0:1], 56
    s_getpc_b64 s[46:47]
L_pc:
    v_lshrrev_b32 v2, 6, v0
    v_and_b32 v1, 63, v0
    s_lshr_b32 s37, s2, 3
    v_readfirstlane_b32 s3, v2
    v_lshlrev_b32 v3, 4, v1
    s_mov_b64 s[14:15], s[46:47]
    s_add_u32 s46, s46, L_vtab-L_pc
    s_addc_u32 s47, s47, L_vtab@rel32@hi+12
    s_and_b32 s44, s37, 15
    s_lshl_b32 s44, s44, 13
    s_sub_u32 s45, s44, 32768
    s_cselect_b32 s44, s44, s45
    s_cselect_b64 s[34:35], s[14:15], s[46:47]
    s_cselect_b32 s45, L_code_end-L_pc-16, -1
    v_lshl_add_u32 v24, v0, 4, s44
    v_min_u32 v24, s45, v24
    global_load_dwordx4 v[112:115], v24, s[34:35]
    v_mul_u32_u24 v23, 8192, v2
    v_add_u32 v23, v23, v3
    global_load_dwordx4 v[8:11], v23, s[46:47]
    global_load_dwordx4 v[16:19], v23, s[46:47] offset:1024
    v_lshrrev_b32 v7, 3, v1
    v_and_b32 v4, 7, v1
    v_lshrrev_b32 v5, 1, v7
    v_xor_b32 v6, v4, v5
    v_lshlrev_b32 v6, 4, v6
    v_lshl_add_u32 v20, v7, 10, v6
    v_xor_b32 v21, 64, v20
    v_add_u32 v21, 7168, v21
    v_lshrrev_b32 v6, 2, v1
    v_and_b32 v6, 4, v6
    v_xor_b32 v6, v4, v6
    v_mul_u32_u24 v7, 3072, v7
    v_lshl_add_u32 v22, v6, 4, v7
    s_and_b32 s42, s37, 1
    s_lshr_b32 s38, s2, 5
    s_and_b32 s44, s2, 4
    s_lshl1_add_u32 s38, s44, s38
    s_lshl1_add_u32 s37, s37, s38
    s_lshl3_add_u32 s38, s38, s3
    s_lshl_b32 s38, s38, 14
    s_mul_i32 s39, s3, 24576
    s_lshl_b32 s40, s3, 11
    s_lshl_b32 s41, s3, 10
    s_and_b32 s44, s2, 3
    s_bfe_u32 s45, s2, 0x10004
    s_lshl1_add_u32 s44, s44, s45
    s_lshl_b32 s44, s44, 7
    s_xor_b32 s45, s44, 512
    s_lshl_b32 s14, s42, 10
    s_add_u32 s15, s14, s44
    s_sub_u32 s14, s45, s14
    s_add_u32 s14, s14, 1024
    s_cmp_eq_u32 s42, 0
    s_cselect_b32 s44, s45, s44
    s_add_u32 s44, s44, 1024
    s_sub_u32 s22, 0x180000, s14
    s_sub_u32 s26, 0x180000, s44
    s_sub_u32 s30, 0x180000, s15
    s_mov_b32 s23, 0x00020000
    s_mov_b32 s27, 0x00020000
    s_mov_b32 s31, 0x00020000
    s_mov_b32 s18, 0x200000
    s_mov_b32 s19, 0x00020000
    s_cmp_eq_u32 s42, 0
    s_waitcnt lgkmcnt(0)
    s_cselect_b64 s[24:25], s[6:7], s[10:11]
    s_mov_b64 s[16:17], s[4:5]
    s_add_u32 s20, s6, s14
    s_addc_u32 s21, s7, 0
    s_add_u32 s24, s24, s44
    s_addc_u32 s25, s25, 0
    s_add_u32 s28, s10, s15
    s_addc_u32 s29, s11, 0
    s_add_u32 m0, s40, 0
    s_add_u32 s4, s37, 0
    s_and_b32 s4, s4, 7
    s_lshl_b32 s5, s4, 7
    s_add_u32 s5, s5, s38
    buffer_load_dwordx4 v20, s[16:19], s5 offen lds
    buffer_load_dwordx4 v21, s[16:19], s5 offen offset:1024 lds
    s_add_u32 m0, s40, 16384
    s_mul_i32 s6, s4, 196608
    s_add_u32 s6, s6, s39
    buffer_load_dwordx4 v22, s[28:31], s6 offen lds
    buffer_load_dwordx4 v22, s[24:27], s6 offen offset:1024 lds
    s_load_dword s36, s[32:33], 0
    s_lshl3_add_u32 s44, s2, s3
    s_lshl_b32 s44, s44, 7
    s_add_u32 s44, s44, 65536
    s_load_dwordx16 s[48:63], s[46:47], s44
    s_load_dwordx16 s[64:79], s[46:47], s44 offset:64
    s_barrier
    s_add_u32 m0, s40, 32768
    s_add_u32 s4, s37, 1
    s_and_b32 s4, s4, 7
    s_lshl_b32 s5, s4, 7
    s_add_u32 s5, s5, s38
    buffer_load_dwordx4 v20, s[16:19], s5 offen lds
    buffer_load_dwordx4 v21, s[16:19], s5 offen offset:1024 lds
    s_add_u32 m0, s40, 49152
    s_mul_i32 s6, s4, 196608
    s_add_u32 s6, s6, s39
    buffer_load_dwordx4 v22, s[28:31], s6 offen lds
    buffer_load_dwordx4 v22, s[24:27], s6 offen offset:1024 lds
    s_mov_b32 s34, 34603008
    s_mov_b32 s35, 0x00020000
    s_mov_b32 s14, 0x0000ffff
    s_mov_b32 s15, 0x0000ffff
    s_mov_b32 s10, 0x3fb8aa3b
    s_mov_b32 s11, 0x3eb8aa3b
    s_mov_b32 s43, 0
    s_waitcnt vmcnt(4)
    s_barrier
    ds_read_b128 v[120:123], v8 offset:0
    ds_read_b64_tr_b16 v[32:33], v16 offset:0
    ds_read_b64_tr_b16 v[34:35], v16 offset:512
    ds_read_b64_tr_b16 v[36:37], v16 offset:1024
    ds_read_b64_tr_b16 v[38:39], v16 offset:1536
    ds_read_b128 v[124:127], v9 offset:0
    ds_read_b64_tr_b16 v[40:41], v16 offset:4096
    ds_read_b64_tr_b16 v[42:43], v16 offset:4608
    ds_read_b64_tr_b16 v[44:45], v16 offset:5120
    ds_read_b64_tr_b16 v[46:47], v16 offset:5632
    s_waitcnt lgkmcnt(5)
    v_mfma_f32_32x32x16_bf16 v[96:111], v[32:35], v[120:123], 0
    ds_read_b128 v[128:131], v10 offset:0
    ds_read_b64_tr_b16 v[48:49], v16 offset:8192
    ds_read_b64_tr_b16 v[50:51], v16 offset:8704
    v_mfma_f32_32x32x16_bf16 v[80:95], v[120:123], v[36:39], 0
    ds_read_b64_tr_b16 v[52:53], v16 offset:9216
    ds_read_b64_tr_b16 v[54:55], v16 offset:9728
    v_add_u32 v12, 65536, v8
    v_add_u32 v13, 65536, v9
    v_add_u32 v14, 65536, v10
    v_add_u32 v15, 65536, v11
    v_add_u32 v7, 4096, v23
    s_add_u32 m0, s40, 65536
    s_add_u32 s4, s37, 2
    s_and_b32 s4, s4, 7
    s_lshl_b32 s5, s4, 7
    s_add_u32 s5, s5, s38
    buffer_load_dwordx4 v20, s[16:19], s5 offen lds
    buffer_load_dwordx4 v21, s[16:19], s5 offen offset:1024 lds
    s_waitcnt lgkmcnt(5)
    v_mfma_f32_32x32x16_bf16 v[96:111], v[40:43], v[124:127], v[96:111]
    ds_read_b128 v[132:135], v11 offset:0
    ds_read_b64_tr_b16 v[32:33], v16 offset:12288
    ds_read_b64_tr_b16 v[34:35], v16 offset:12800
    v_mfma_f32_32x32x16_bf16 v[80:95], v[124:127], v[44:47], v[80:95]
    ds_read_b64_tr_b16 v[36:37], v16 offset:13312
    ds_read_b64_tr_b16 v[38:39], v16 offset:13824
    s_add_u32 m0, s40, 81920
    s_mul_i32 s6, s4, 196608
    s_add_u32 s6, s6, s39
    buffer_load_dwordx4 v22, s[28:31], s6 offen lds
    buffer_load_dwordx4 v22, s[24:27], s6 offen offset:1024 lds
    s_waitcnt vmcnt(4) lgkmcnt(0)
    s_barrier
    s_add_u32 s36, s36, 0x9e3779b1
    v_mfma_f32_32x32x16_bf16 v[96:111], v[48:51], v[128:131], v[96:111]
    ds_read_b128 v[136:139], v8 offset:32768
    ds_read_b64_tr_b16 v[40:41], v16 offset:32768
    ds_read_b64_tr_b16 v[42:43], v16 offset:33280
    v_mfma_f32_32x32x16_bf16 v[80:95], v[128:131], v[52:55], v[80:95]
    ds_read_b64_tr_b16 v[44:45], v16 offset:33792
    ds_read_b64_tr_b16 v[46:47], v16 offset:34304
    s_add_u32 m0, s40, 98304
    s_add_u32 s4, s37, 3
    s_and_b32 s4, s4, 7
    s_lshl_b32 s5, s4, 7
    s_add_u32 s5, s5, s38
    buffer_load_dwordx4 v20, s[16:19], s5 offen lds
    buffer_load_dwordx4 v21, s[16:19], s5 offen offset:1024 lds
    v_mfma_f32_32x32x16_bf16 v[96:111], v[32:35], v[132:135], v[96:111]
    ds_read_b128 v[140:143], v9 offset:32768
    ds_read_b64_tr_b16 v[48:49], v16 offset:36864
    ds_read_b64_tr_b16 v[50:51], v16 offset:37376
    v_mfma_f32_32x32x16_bf16 v[80:95], v[132:135], v[36:39], v[80:95]
    ds_read_b64_tr_b16 v[52:53], v16 offset:37888
    ds_read_b64_tr_b16 v[54:55], v16 offset:38400
    s_add_u32 m0, s40, 114688
    s_mul_i32 s6, s4, 196608
    s_add_u32 s6, s6, s39
    buffer_load_dwordx4 v22, s[28:31], s6 offen lds
    buffer_load_dwordx4 v22, s[24:27], s6 offen offset:1024 lds
    s_waitcnt lgkmcnt(5)
    v_mfma_f32_32x32x16_bf16 v[96:111], v[40:43], v[136:139], v[96:111]
    ds_read_b128 v[144:147], v10 offset:32768
    ds_read_b64_tr_b16 v[32:33], v16 offset:40960
    ds_read_b64_tr_b16 v[34:35], v16 offset:41472
    v_mfma_f32_32x32x16_bf16 v[80:95], v[136:139], v[44:47], v[80:95]
    ds_read_b64_tr_b16 v[36:37], v16 offset:41984
    ds_read_b64_tr_b16 v[38:39], v16 offset:42496
    s_add_u32 m0, s40, 0
    s_add_u32 s4, s37, 4
    s_and_b32 s4, s4, 7
    s_lshl_b32 s5, s4, 7
    s_add_u32 s5, s5, s38
    buffer_load_dwordx4 v20, s[16:19], s5 offen lds
    buffer_load_dwordx4 v21, s[16:19], s5 offen offset:1024 lds
    s_waitcnt lgkmcnt(5)
    v_mfma_f32_32x32x16_bf16 v[96:111], v[48:51], v[140:143], v[96:111]
    ds_read_b128 v[148:151], v11 offset:32768
    ds_read_b64_tr_b16 v[40:41], v16 offset:45056
    ds_read_b64_tr_b16 v[42:43], v16 offset:45568
    v_mfma_f32_32x32x16_bf16 v[80:95], v[140:143], v[52:55], v[80:95]
    ds_read_b64_tr_b16 v[44:45], v16 offset:46080
    ds_read_b64_tr_b16 v[46:47], v16 offset:46592
    s_add_u32 m0, s40, 16384
    s_mul_i32 s6, s4, 196608
    s_add_u32 s6, s6, s39
    buffer_load_dwordx4 v22, s[28:31], s6 offen lds
    buffer_load_dwordx4 v22, s[24:27], s6 offen offset:1024 lds
    s_waitcnt vmcnt(8) lgkmcnt(0)
    s_barrier
    v_mfma_f32_32x32x16_bf16 v[96:111], v[32:35], v[144:147], v[96:111]
    ds_read_b128 v[152:155], v12 offset:0
    ds_read_b64_tr_b16 v[48:49], v17 offset:0
    ds_read_b64_tr_b16 v[50:51], v17 offset:512
    v_mfma_f32_32x32x16_bf16 v[80:95], v[144:147], v[36:39], v[80:95]
    ds_read_b64_tr_b16 v[52:53], v17 offset:1024
    ds_read_b64_tr_b16 v[54:55], v17 offset:1536
    s_add_u32 m0, s40, 32768
    s_add_u32 s4, s37, 5
    s_and_b32 s4, s4, 7
    s_lshl_b32 s5, s4, 7
    s_add_u32 s5, s5, s38
    buffer_load_dwordx4 v20, s[16:19], s5 offen lds
    buffer_load_dwordx4 v21, s[16:19], s5 offen offset:1024 lds
    v_mfma_f32_32x32x16_bf16 v[96:111], v[40:43], v[148:151], v[96:111]
    ds_read_b128 v[156:159], v13 offset:0
    ds_read_b64_tr_b16 v[32:33], v17 offset:4096
    ds_read_b64_tr_b16 v[34:35], v17 offset:4608
    v_mfma_f32_32x32x16_bf16 v[80:95], v[148:151], v[44:47], v[80:95]
    ds_read_b64_tr_b16 v[36:37], v17 offset:5120
    ds_read_b64_tr_b16 v[38:39], v17 offset:5632
    v_add_u32 v6, s73, v3
    global_load_dword v4, v6, s[8:9]
    global_load_dword v0, v3, s[12:13]
    s_waitcnt lgkmcnt(5)
    v_mfma_f32_32x32x16_bf16 v[96:111], v[48:51], v[152:155], v[96:111]
    ds_read_b128 v[160:163], v14 offset:0
    ds_read_b64_tr_b16 v[40:41], v17 offset:8192
    ds_read_b64_tr_b16 v[42:43], v17 offset:8704
    v_mfma_f32_32x32x16_bf16 v[80:95], v[152:155], v[52:55], v[80:95]
    ds_read_b64_tr_b16 v[44:45], v17 offset:9216
    ds_read_b64_tr_b16 v[46:47], v17 offset:9728
    s_add_u32 m0, s40, 49152
    s_mul_i32 s6, s4, 196608
    s_add_u32 s6, s6, s39
    buffer_load_dwordx4 v22, s[28:31], s6 offen lds
    buffer_load_dwordx4 v22, s[24:27], s6 offen offset:1024 lds
    s_waitcnt lgkmcnt(5)
    v_mfma_f32_32x32x16_bf16 v[96:111], v[32:35], v[156:159], v[96:111]
    ds_read_b128 v[164:167], v15 offset:0
    ds_read_b64_tr_b16 v[48:49], v17 offset:12288
    ds_read_b64_tr_b16 v[50:51], v17 offset:12800
    v_mfma_f32_32x32x16_bf16 v[80:95], v[156:159], v[36:39], v[80:95]
    ds_read_b64_tr_b16 v[52:53], v17 offset:13312
    ds_read_b64_tr_b16 v[54:55], v17 offset:13824
    s_waitcnt vmcnt(10) lgkmcnt(0)
    s_barrier
    v_mfma_f32_32x32x16_bf16 v[96:111], v[40:43], v[160:163], v[96:111]
    ds_read_b128 v[168:171], v12 offset:32768
    ds_read_b64_tr_b16 v[32:33], v17 offset:32768
    ds_read_b64_tr_b16 v[34:35], v17 offset:33280
    v_mfma_f32_32x32x16_bf16 v[80:95], v[160:163], v[44:47], v[80:95]
    ds_read_b64_tr_b16 v[36:37], v17 offset:33792
    ds_read_b64_tr_b16 v[38:39], v17 offset:34304
    s_add_u32 m0, s40, 65536
    s_add_u32 s4, s37, 6
    s_and_b32 s4, s4, 7
    s_lshl_b32 s5, s4, 7
    s_add_u32 s5, s5, s38
    buffer_load_dwordx4 v20, s[16:19], s5 offen lds
    buffer_load_dwordx4 v21, s[16:19], s5 offen offset:1024 lds
    v_mfma_f32_32x32x16_bf16 v[96:111], v[48:51], v[164:167], v[96:111]
    ds_read_b128 v[172:175], v13 offset:32768
    ds_read_b64_tr_b16 v[40:41], v17 offset:36864
    ds_read_b64_tr_b16 v[42:43], v17 offset:37376
    v_mfma_f32_32x32x16_bf16 v[80:95], v[164:167], v[52:55], v[80:95]
    ds_read_b64_tr_b16 v[44:45], v17 offset:37888
    ds_read_b64_tr_b16 v[46:47], v17 offset:38400
    s_waitcnt lgkmcnt(5)
    v_mfma_f32_32x32x16_bf16 v[96:111], v[32:35], v[168:171], v[96:111]
    ds_read_b128 v[176:179], v14 offset:32768
    ds_read_b64_tr_b16 v[48:49], v17 offset:40960
    ds_read_b64_tr_b16 v[50:51], v17 offset:41472
    v_mfma_f32_32x32x16_bf16 v[80:95], v[168:171], v[36:39], v[80:95]
    ds_read_b64_tr_b16 v[52:53], v17 offset:41984
    ds_read_b64_tr_b16 v[54:55], v17 offset:42496
    s_add_u32 m0, s40, 81920
    s_mul_i32 s6, s4, 196608
    s_add_u32 s6, s6, s39
    buffer_load_dwordx4 v22, s[28:31], s6 offen lds
    buffer_load_dwordx4 v22, s[24:27], s6 offen offset:1024 lds
    s_waitcnt lgkmcnt(5)
    v_mfma_f32_32x32x16_bf16 v[96:111], v[40:43], v[172:175], v[96:111]
    ds_read_b128 v[180:183], v15 offset:32768
    ds_read_b64_tr_b16 v[32:33], v17 offset:45056
    ds_read_b64_tr_b16 v[34:35], v17 offset:45568
    v_mfma_f32_32x32x16_bf16 v[80:95], v[172:175], v[44:47], v[80:95]
    ds_read_b64_tr_b16 v[36:37], v17 offset:46080
    ds_read_b64_tr_b16 v[38:39], v17 offset:46592
    s_waitcnt vmcnt(10) lgkmcnt(0)
    s_barrier
    v_mfma_f32_32x32x16_bf16 v[96:111], v[48:51], v[176:179], v[96:111]
    ds_read_b128 v[184:187], v8 offset:0
    ds_read_b64_tr_b16 v[40:41], v16 offset:0
    ds_read_b64_tr_b16 v[42:43], v16 offset:512
    v_mfma_f32_32x32x16_bf16 v[80:95], v[176:179], v[52:55], v[80:95]
    ds_read_b64_tr_b16 v[44:45], v16 offset:1024
    ds_read_b64_tr_b16 v[46:47], v16 offset:1536
    s_add_u32 m0, s40, 98304
    s_add_u32 s4, s37, 7
    s_and_b32 s4, s4, 7
    s_lshl_b32 s5, s4, 7
    s_add_u32 s5, s5, s38
    buffer_load_dwordx4 v20, s[16:19], s5 offen lds
    buffer_load_dwordx4 v21, s[16:19], s5 offen offset:1024 lds
    v_mfma_f32_32x32x16_bf16 v[96:111], v[32:35], v[180:183], v[96:111]
    ds_read_b128 v[188:191], v9 offset:0
    ds_read_b64_tr_b16 v[48:49], v16 offset:4096
    ds_read_b64_tr_b16 v[50:51], v16 offset:4608
    v_mfma_f32_32x32x16_bf16 v[80:95], v[180:183], v[36:39], v[80:95]
    ds_read_b64_tr_b16 v[52:53], v16 offset:5120
    ds_read_b64_tr_b16 v[54:55], v16 offset:5632
    s_add_u32 m0, s40, 114688
    s_mul_i32 s6, s4, 196608
    s_add_u32 s6, s6, s39
    buffer_load_dwordx4 v22, s[28:31], s6 offen lds
    buffer_load_dwordx4 v22, s[24:27], s6 offen offset:1024 lds
    s_waitcnt lgkmcnt(5)
    v_mfma_f32_32x32x16_bf16 v[96:111], v[40:43], v[184:187], v[96:111]
    ds_read_b128 v[192:195], v10 offset:0
    ds_read_b64_tr_b16 v[32:33], v16 offset:8192
    ds_read_b64_tr_b16 v[34:35], v16 offset:8704
    v_mfma_f32_32x32x16_bf16 v[80:95], v[184:187], v[44:47], v[80:95]
    ds_read_b64_tr_b16 v[36:37], v16 offset:9216
    ds_read_b64_tr_b16 v[38:39], v16 offset:9728
    s_add_u32 m0, s41, 131072
    s_add_u32 s5, s37, 0
    s_and_b32 s5, s5, 7
    s_mul_i32 s5, s5, 196608
    s_add_u32 s5, s5, s39
    buffer_load_dwordx4 v22, s[20:23], s5 offen lds
    s_waitcnt lgkmcnt(5)
    v_mfma_f32_32x32x16_bf16 v[96:111], v[48:51], v[188:191], v[96:111]
    ds_read_b128 v[196:199], v11 offset:0
    ds_read_b64_tr_b16 v[40:41], v16 offset:12288
    ds_read_b64_tr_b16 v[42:43], v16 offset:12800
    v_mfma_f32_32x32x16_bf16 v[80:95], v[188:191], v[52:55], v[80:95]
    ds_read_b64_tr_b16 v[44:45], v16 offset:13312
    ds_read_b64_tr_b16 v[46:47], v16 offset:13824
    s_add_u32 m0, s41, 139264
    s_add_u32 s5, s37, 1
    s_and_b32 s5, s5, 7
    s_mul_i32 s5, s5, 196608
    s_add_u32 s5, s5, s39
    buffer_load_dwordx4 v22, s[20:23], s5 offen lds
    s_waitcnt vmcnt(10) lgkmcnt(0)
    s_barrier
    v_mfma_f32_32x32x16_bf16 v[96:111], v[32:35], v[192:195], v[96:111]
    ds_read_b128 v[200:203], v8 offset:32768
    ds_read_b64_tr_b16 v[48:49], v16 offset:32768
    ds_read_b64_tr_b16 v[50:51], v16 offset:33280
    v_mfma_f32_32x32x16_bf16 v[80:95], v[192:195], v[36:39], v[80:95]
    ds_read_b64_tr_b16 v[52:53], v16 offset:33792
    ds_read_b64_tr_b16 v[54:55], v16 offset:34304
    s_add_u32 m0, s41, 147456
    s_add_u32 s5, s37, 2
    s_and_b32 s5, s5, 7
    s_mul_i32 s5, s5, 196608
    s_add_u32 s5, s5, s39
    buffer_load_dwordx4 v22, s[20:23], s5 offen lds
    v_mfma_f32_32x32x16_bf16 v[96:111], v[40:43], v[196:199], v[96:111]
    ds_read_b128 v[204:207], v9 offset:32768
    ds_read_b64_tr_b16 v[32:33], v16 offset:36864
    ds_read_b64_tr_b16 v[34:35], v16 offset:37376
    v_mfma_f32_32x32x16_bf16 v[80:95], v[196:199], v[44:47], v[80:95]
    ds_read_b64_tr_b16 v[36:37], v16 offset:37888
    ds_read_b64_tr_b16 v[38:39], v16 offset:38400
    s_add_u32 m0, s41, 155648
    s_add_u32 s5, s37, 3
    s_and_b32 s5, s5, 7
    s_mul_i32 s5, s5, 196608
    s_add_u32 s5, s5, s39
    buffer_load_dwordx4 v22, s[20:23], s5 offen lds
    s_waitcnt lgkmcnt(5)
    v_mfma_f32_32x32x16_bf16 v[96:111], v[48:51], v[200:203], v[96:111]
    ds_read_b128 v[208:211], v10 offset:32768
    ds_read_b64_tr_b16 v[40:41], v16 offset:40960
    ds_read_b64_tr_b16 v[42:43], v16 offset:41472
    v_mfma_f32_32x32x16_bf16 v[80:95], v[200:203], v[52:55], v[80:95]
    ds_read_b64_tr_b16 v[44:45], v16 offset:41984
    ds_read_b64_tr_b16 v[46:47], v16 offset:42496
    s_add_u32 m0, s41, 16384
    s_add_u32 s5, s37, 4
    s_and_b32 s5, s5, 7
    s_mul_i32 s5, s5, 196608
    s_add_u32 s5, s5, s39
    buffer_load_dwordx4 v22, s[20:23], s5 offen lds
    s_waitcnt lgkmcnt(5)
    v_mfma_f32_32x32x16_bf16 v[96:111], v[32:35], v[204:207], v[96:111]
    ds_read_b128 v[212:215], v11 offset:32768
    ds_read_b64_tr_b16 v[48:49], v16 offset:45056
    ds_read_b64_tr_b16 v[50:51], v16 offset:45568
    v_mfma_f32_32x32x16_bf16 v[80:95], v[204:207], v[36:39], v[80:95]
    ds_read_b64_tr_b16 v[52:53], v16 offset:46080
    ds_read_b64_tr_b16 v[54:55], v16 offset:46592
    s_add_u32 m0, s41, 24576
    s_add_u32 s5, s37, 5
    s_and_b32 s5, s5, 7
    s_mul_i32 s5, s5, 196608
    s_add_u32 s5, s5, s39
    buffer_load_dwordx4 v22, s[20:23], s5 offen lds
    s_waitcnt vmcnt(6) lgkmcnt(0)
    s_barrier
    v_mfma_f32_32x32x16_bf16 v[96:111], v[40:43], v[208:211], v[96:111]
    ds_read_b128 v[216:219], v12 offset:0
    ds_read_b64_tr_b16 v[32:33], v17 offset:0
    ds_read_b64_tr_b16 v[34:35], v17 offset:512
    v_mfma_f32_32x32x16_bf16 v[80:95], v[208:211], v[44:47], v[80:95]
    ds_read_b64_tr_b16 v[36:37], v17 offset:1024
    ds_read_b64_tr_b16 v[38:39], v17 offset:1536
    s_add_u32 m0, s41, 49152
    s_add_u32 s5, s37, 6
    s_and_b32 s5, s5, 7
    s_mul_i32 s5, s5, 196608
    s_add_u32 s5, s5, s39
    buffer_load_dwordx4 v22, s[20:23], s5 offen lds
    v_mfma_f32_32x32x16_bf16 v[96:111], v[48:51], v[212:215], v[96:111]
    ds_read_b128 v[220:223], v13 offset:0
    ds_read_b64_tr_b16 v[40:41], v17 offset:4096
    ds_read_b64_tr_b16 v[42:43], v17 offset:4608
    v_mfma_f32_32x32x16_bf16 v[80:95], v[212:215], v[52:55], v[80:95]
    ds_read_b64_tr_b16 v[44:45], v17 offset:5120
    ds_read_b64_tr_b16 v[46:47], v17 offset:5632
    s_add_u32 m0, s41, 57344
    s_add_u32 s5, s37, 7
    s_and_b32 s5, s5, 7
    s_mul_i32 s5, s5, 196608
    s_add_u32 s5, s5, s39
    buffer_load_dwordx4 v22, s[20:23], s5 offen lds
    s_waitcnt lgkmcnt(5)
    v_mfma_f32_32x32x16_bf16 v[96:111], v[32:35], v[216:219], v[96:111]
    ds_read_b128 v[224:227], v14 offset:0
    ds_read_b64_tr_b16 v[48:49], v17 offset:8192
    ds_read_b64_tr_b16 v[50:51], v17 offset:8704
    v_mfma_f32_32x32x16_bf16 v[80:95], v[216:219], v[36:39], v[80:95]
    ds_read_b64_tr_b16 v[52:53], v17 offset:9216
    ds_read_b64_tr_b16 v[54:55], v17 offset:9728
    s_and_b32 s5, s73, 1024
    s_add_u32 m0, s5, 8192
    v_add_u32 v6, s73, v3
    global_load_lds_dwordx4 v6, s[8:9]
    global_load_dwordx4 v[28:31], v7, s[46:47] offset:-1024
    s_waitcnt lgkmcnt(5)
    v_mfma_f32_32x32x16_bf16 v[96:111], v[40:43], v[220:223], v[96:111]
    ds_read_b128 v[228:231], v15 offset:0
    ds_read_b64_tr_b16 v[32:33], v17 offset:12288
    ds_read_b64_tr_b16 v[34:35], v17 offset:12800
    v_mfma_f32_32x32x16_bf16 v[80:95], v[220:223], v[44:47], v[80:95]
    ds_read_b64_tr_b16 v[36:37], v17 offset:13312
    ds_read_b64_tr_b16 v[38:39], v17 offset:13824
    v_subrev_u32 v5, 114688, v19
    s_waitcnt lgkmcnt(5)
    v_mfma_f32_32x32x16_bf16 v[96:111], v[48:51], v[224:227], v[96:111]
    ds_read_b128 v[232:235], v12 offset:32768
    ds_read_b64_tr_b16 v[40:41], v17 offset:32768
    ds_read_b64_tr_b16 v[42:43], v17 offset:33280
    v_mfma_f32_32x32x16_bf16 v[80:95], v[224:227], v[52:55], v[80:95]
    ds_read_b64_tr_b16 v[44:45], v17 offset:33792
    ds_read_b64_tr_b16 v[46:47], v17 offset:34304
    global_load_dwordx4 v[24:27], v7, s[46:47] offset:-2048
    s_waitcnt lgkmcnt(5)
    v_mfma_f32_32x32x16_bf16 v[96:111], v[32:35], v[228:231], v[96:111]
    ds_read_b128 v[236:239], v13 offset:32768
    ds_read_b64_tr_b16 v[48:49], v17 offset:36864
    ds_read_b64_tr_b16 v[50:51], v17 offset:37376
    v_mfma_f32_32x32x16_bf16 v[80:95], v[228:231], v[36:39], v[80:95]
    ds_read_b64_tr_b16 v[52:53], v17 offset:37888
    ds_read_b64_tr_b16 v[54:55], v17 offset:38400
    global_load_dwordx4 v[56:59], v7, s[46:47] offset:0
    s_waitcnt lgkmcnt(5)
    v_mfma_f32_32x32x16_bf16 v[96:111], v[40:43], v[232:235], v[96:111]
    ds_read_b128 v[240:243], v14 offset:32768
    ds_read_b64_tr_b16 v[32:33], v17 offset:40960
    ds_read_b64_tr_b16 v[34:35], v17 offset:41472
    v_mfma_f32_32x32x16_bf16 v[80:95], v[232:235], v[44:47], v[80:95]
    ds_read_b64_tr_b16 v[36:37], v17 offset:41984
    ds_read_b64_tr_b16 v[38:39], v17 offset:42496
    global_load_dwordx4 v[60:63], v7, s[46:47] offset:1024
    s_waitcnt lgkmcnt(5)
    v_mfma_f32_32x32x16_bf16 v[96:111], v[48:51], v[236:239], v[96:111]
    ds_read_b128 v[244:247], v15 offset:32768
    ds_read_b64_tr_b16 v[40:41], v17 offset:45056
    ds_read_b64_tr_b16 v[42:43], v17 offset:45568
    v_mfma_f32_32x32x16_bf16 v[80:95], v[236:239], v[52:55], v[80:95]
    ds_read_b64_tr_b16 v[44:45], v17 offset:46080
    ds_read_b64_tr_b16 v[46:47], v17 offset:46592
    s_waitcnt vmcnt(4) lgkmcnt(0)
    s_barrier
    v_mfma_f32_32x32x16_bf16 v[96:111], v[32:35], v[240:243], v[96:111]
    ds_read_b64_tr_b16 v[112:113], v19 offset:0
    ds_read_b64_tr_b16 v[114:115], v19 offset:512
    v_mfma_f32_32x32x16_bf16 v[80:95], v[240:243], v[36:39], v[80:95]
    v_mov_b64 v[8:9], -1
    v_mov_b64 v[10:11], -1
    buffer_store_dwordx4 v[8:11], v3, s[32:35], s61 offen sc1
    v_mfma_f32_32x32x16_bf16 v[96:111], v[40:43], v[244:247], v[96:111]
    ds_read_b64_tr_b16 v[116:117], v19 offset:2048
    ds_read_b64_tr_b16 v[118:119], v19 offset:2560
    ds_read_b64_tr_b16 v[248:249], v19 offset:4096
    v_mfma_f32_32x32x16_bf16 v[80:95], v[244:247], v[44:47], v[80:95]
    ds_read_b64_tr_b16 v[250:251], v19 offset:4608
    ds_read_b64_tr_b16 v[252:253], v19 offset:6144
    ds_read_b64_tr_b16 v[254:255], v19 offset:6656
    s_waitcnt lgkmcnt(6)
    v_mfma_f32_32x32x16_bf16 v[64:79], v[112:115], v[120:123], 0
    ds_read_b64_tr_b16 v[120:121], v19 offset:8192
    ds_read_b64_tr_b16 v[122:123], v19 offset:8704
    s_waitcnt lgkmcnt(6)
    v_mfma_f32_32x32x16_bf16 v[64:79], v[116:119], v[124:127], v[64:79]
    ds_read_b64_tr_b16 v[124:125], v19 offset:10240
    ds_read_b64_tr_b16 v[126:127], v19 offset:10752
    s_nop 0
    v_cvt_pk_bf16_f32 v40, v80, v81
    v_cvt_pk_bf16_f32 v41, v82, v83
    v_cvt_pk_bf16_f32 v42, v84, v85
    v_cvt_pk_bf16_f32 v43, v86, v87
    v_cvt_pk_bf16_f32 v44, v88, v89
    v_cvt_pk_bf16_f32 v45, v90, v91
    v_cvt_pk_bf16_f32 v46, v92, v93
    v_cvt_pk_bf16_f32 v47, v94, v95
    s_add_u32 s5, s53, 65536
    s_cmp_eq_u32 s42, 0
    s_waitcnt vmcnt(3)
    s_cbranch_scc1 L_p1_q
    buffer_store_dwordx4 v[40:43], v25, s[32:35], s52 offen sc1
    buffer_store_dwordx4 v[44:47], v25, s[32:35], s52 offen offset:512 sc1
    s_branch L_p1_qk
L_p1_q:
    v_pk_mul_f32 v[96:97], v[96:97], s[10:11] op_sel:[0,1]
    v_pk_mul_f32 v[98:99], v[98:99], s[10:11] op_sel:[0,1]
    v_pk_mul_f32 v[100:101], v[100:101], s[10:11] op_sel:[0,1]
    v_pk_mul_f32 v[102:103], v[102:103], s[10:11] op_sel:[0,1]
    v_pk_mul_f32 v[104:105], v[104:105], s[10:11] op_sel:[0,1]
    v_pk_mul_f32 v[106:107], v[106:107], s[10:11] op_sel:[0,1]
    v_pk_mul_f32 v[108:109], v[108:109], s[10:11] op_sel:[0,1]
    v_pk_mul_f32 v[110:111], v[110:111], s[10:11] op_sel:[0,1]
    v_mov_b32 v24, v3
L_p1_qk:
    s_waitcnt lgkmcnt(6)
    v_mfma_f32_32x32x16_bf16 v[64:79], v[248:251], v[128:131], v[64:79]
    ds_read_b64_tr_b16 v[128:129], v19 offset:12288
    ds_read_b64_tr_b16 v[130:131], v19 offset:12800
    v_cvt_pk_bf16_f32 v32, v96, v97
    v_cvt_pk_bf16_f32 v33, v98, v99
    v_cvt_pk_bf16_f32 v34, v100, v101
    v_cvt_pk_bf16_f32 v35, v102, v103
    buffer_store_dwordx4 v[32:35], v24, s[32:35], s53 offen sc1
    s_waitcnt lgkmcnt(6)
    v_mfma_f32_32x32x16_bf16 v[64:79], v[252:255], v[132:135], v[64:79]
    ds_read_b64_tr_b16 v[132:133], v19 offset:14336
    ds_read_b64_tr_b16 v[134:135], v19 offset:14848
    v_cvt_pk_bf16_f32 v36, v104, v105
    v_cvt_pk_bf16_f32 v37, v106, v107
    v_cvt_pk_bf16_f32 v38, v108, v109
    v_cvt_pk_bf16_f32 v39, v110, v111
    buffer_store_dwordx4 v[36:39], v24, s[32:35], s5 offen sc1
    s_waitcnt lgkmcnt(6)
    v_mfma_f32_32x32x16_bf16 v[64:79], v[120:123], v[136:139], v[64:79]
    ds_read_b64_tr_b16 v[136:137], v19 offset:16384
    ds_read_b64_tr_b16 v[138:139], v19 offset:16896
    s_waitcnt lgkmcnt(6)
    v_mfma_f32_32x32x16_bf16 v[64:79], v[124:127], v[140:143], v[64:79]
    ds_read_b64_tr_b16 v[140:141], v19 offset:18432
    ds_read_b64_tr_b16 v[142:143], v19 offset:18944
    v_mov_b32 v6, 0x3f803f80
    v_cndmask_b32 v96, v6, v40, s[14:15]
    v_cndmask_b32 v104, v40, v6, s[14:15]
    s_waitcnt lgkmcnt(6)
    v_mfma_f32_32x32x16_bf16 v[64:79], v[128:131], v[144:147], v[64:79]
    ds_read_b64_tr_b16 v[144:145], v19 offset:20480
    ds_read_b64_tr_b16 v[146:147], v19 offset:20992
    v_cndmask_b32 v97, v6, v41, s[14:15]
    v_cndmask_b32 v105, v41, v6, s[14:15]
    v_cndmask_b32 v98, v6, v42, s[14:15]
    s_waitcnt lgkmcnt(6)
    v_mfma_f32_32x32x16_bf16 v[64:79], v[132:135], v[148:151], v[64:79]
    ds_read_b64_tr_b16 v[148:149], v19 offset:22528
    ds_read_b64_tr_b16 v[150:151], v19 offset:23040
    v_cndmask_b32 v106, v42, v6, s[14:15]
    v_cndmask_b32 v99, v6, v43, s[14:15]
    v_cndmask_b32 v107, v43, v6, s[14:15]
    s_waitcnt lgkmcnt(6)
    v_mfma_f32_32x32x16_bf16 v[64:79], v[136:139], v[152:155], v[64:79]
    ds_read_b64_tr_b16 v[152:153], v19 offset:24576
    ds_read_b64_tr_b16 v[154:155], v19 offset:25088
    v_cndmask_b32 v100, v6, v44, s[14:15]
    v_cndmask_b32 v108, v44, v6, s[14:15]
    v_cndmask_b32 v101, v6, v45, s[14:15]
    s_waitcnt lgkmcnt(6)
    v_mfma_f32_32x32x16_bf16 v[64:79], v[140:143], v[156:159], v[64:79]
    ds_read_b64_tr_b16 v[156:157], v19 offset:26624
    ds_read_b64_tr_b16 v[158:159], v19 offset:27136
    v_cndmask_b32 v109, v45, v6, s[14:15]
    v_cndmask_b32 v102, v6, v46, s[14:15]
    v_cndmask_b32 v110, v46, v6, s[14:15]
    s_waitcnt lgkmcnt(6)
    v_mfma_f32_32x32x16_bf16 v[64:79], v[144:147], v[160:163], v[64:79]
    ds_read_b64_tr_b16 v[160:161], v19 offset:28672
    ds_read_b64_tr_b16 v[162:163], v19 offset:29184
    v_cndmask_b32 v103, v6, v47, s[14:15]
    v_cndmask_b32 v111, v47, v6, s[14:15]
    s_waitcnt lgkmcnt(6)
    v_mfma_f32_32x32x16_bf16 v[64:79], v[148:151], v[164:167], v[64:79]
    ds_read_b64_tr_b16 v[164:165], v19 offset:30720
    ds_read_b64_tr_b16 v[166:167], v19 offset:31232
    s_waitcnt lgkmcnt(6)
    v_mfma_f32_32x32x16_bf16 v[64:79], v[152:155], v[168:171], v[64:79]
    ds_read_b64_tr_b16 v[168:169], v5 offset:0
    ds_read_b64_tr_b16 v[170:171], v5 offset:512
    s_waitcnt lgkmcnt(6)
    v_mfma_f32_32x32x16_bf16 v[64:79], v[156:159], v[172:175], v[64:79]
    ds_read_b64_tr_b16 v[172:173], v5 offset:2048
    ds_read_b64_tr_b16 v[174:175], v5 offset:2560
    s_waitcnt lgkmcnt(6)
    v_mfma_f32_32x32x16_bf16 v[64:79], v[160:163], v[176:179], v[64:79]
    ds_read_b64_tr_b16 v[176:177], v5 offset:4096
    ds_read_b64_tr_b16 v[178:179], v5 offset:4608
    s_waitcnt lgkmcnt(6)
    v_mfma_f32_32x32x16_bf16 v[64:79], v[164:167], v[180:183], v[64:79]
    ds_read_b64_tr_b16 v[180:181], v5 offset:6144
    ds_read_b64_tr_b16 v[182:183], v5 offset:6656
    s_waitcnt lgkmcnt(6)
    v_mfma_f32_32x32x16_bf16 v[64:79], v[168:171], v[184:187], v[64:79]
    ds_read_b64_tr_b16 v[184:185], v5 offset:8192
    ds_read_b64_tr_b16 v[186:187], v5 offset:8704
    s_waitcnt lgkmcnt(6)
    v_mfma_f32_32x32x16_bf16 v[64:79], v[172:175], v[188:191], v[64:79]
    ds_read_b64_tr_b16 v[188:189], v5 offset:10240
    ds_read_b64_tr_b16 v[190:191], v5 offset:10752
    s_waitcnt lgkmcnt(6)
    v_mfma_f32_32x32x16_bf16 v[64:79], v[176:179], v[192:195], v[64:79]
    ds_read_b64_tr_b16 v[192:193], v5 offset:12288
    ds_read_b64_tr_b16 v[194:195], v5 offset:12800
    s_waitcnt lgkmcnt(6)
    v_mfma_f32_32x32x16_bf16 v[64:79], v[180:183], v[196:199], v[64:79]
    ds_read_b64_tr_b16 v[196:197], v5 offset:14336
    ds_read_b64_tr_b16 v[198:199], v5 offset:14848
    s_waitcnt lgkmcnt(6)
    v_mfma_f32_32x32x16_bf16 v[64:79], v[184:187], v[200:203], v[64:79]
    ds_read_b64_tr_b16 v[200:201], v5 offset:32768
    ds_read_b64_tr_b16 v[202:203], v5 offset:33280
    s_waitcnt lgkmcnt(6)
    v_mfma_f32_32x32x16_bf16 v[64:79], v[188:191], v[204:207], v[64:79]
    ds_read_b64_tr_b16 v[204:205], v5 offset:34816
    ds_read_b64_tr_b16 v[206:207], v5 offset:35328
    s_waitcnt lgkmcnt(6)
    v_mfma_f32_32x32x16_bf16 v[64:79], v[192:195], v[208:211], v[64:79]
    ds_read_b64_tr_b16 v[208:209], v5 offset:36864
    ds_read_b64_tr_b16 v[210:211], v5 offset:37376
    s_waitcnt lgkmcnt(6)
    v_mfma_f32_32x32x16_bf16 v[64:79], v[196:199], v[212:215], v[64:79]
    ds_read_b64_tr_b16 v[212:213], v5 offset:38912
    ds_read_b64_tr_b16 v[214:215], v5 offset:39424
    s_waitcnt lgkmcnt(6)
    v_mfma_f32_32x32x16_bf16 v[64:79], v[200:203], v[216:219], v[64:79]
    ds_read_b64_tr_b16 v[216:217], v5 offset:40960
    ds_read_b64_tr_b16 v[218:219], v5 offset:41472
    s_waitcnt lgkmcnt(6)
    v_mfma_f32_32x32x16_bf16 v[64:79], v[204:207], v[220:223], v[64:79]
    ds_read_b64_tr_b16 v[220:221], v5 offset:43008
    ds_read_b64_tr_b16 v[222:223], v5 offset:43520
    s_waitcnt vmcnt(0)
    s_cmp_lg_u32 s3, 0
    s_barrier
    s_cbranch_scc1 L_f1done
    v_mov_b32 v4, s36
    s_mov_b64 exec, 1
    buffer_store_dword v4, v3, s[32:35], s48 offen sc1
    s_mov_b64 exec, -1
L_f1done:
    s_waitcnt lgkmcnt(6)
    v_mfma_f32_32x32x16_bf16 v[64:79], v[208:211], v[224:227], v[64:79]
    ds_read_b64_tr_b16 v[224:225], v5 offset:45056
    ds_read_b64_tr_b16 v[226:227], v5 offset:45568
    v_lshlrev_b32 v6, 5, v1
    v_and_b32 v4, 0x3ff, v6
    s_cmp_eq_u32 s42, 0
    s_cbranch_scc1 L_skip_gl
    global_load_dwordx4 v[104:107], v4, s[12:13]
    global_load_dwordx4 v[108:111], v4, s[12:13] offset:16
    buffer_load_dwordx4 v[96:99], v6, s[16:19], s71 offen
    buffer_load_dwordx4 v[100:103], v6, s[16:19], s71 offen offset:16
L_skip_gl:
    s_waitcnt lgkmcnt(6)
    v_mfma_f32_32x32x16_bf16 v[64:79], v[212:215], v[228:231], v[64:79]
    ds_read_b64_tr_b16 v[228:229], v5 offset:47104
    ds_read_b64_tr_b16 v[230:231], v5 offset:47616
    ds_read_b64_tr_b16 v[248:249], v18 offset:0
    ds_read_b64_tr_b16 v[250:251], v18 offset:256
    ds_read_b64_tr_b16 v[252:253], v18 offset:512
    ds_read_b64_tr_b16 v[254:255], v18 offset:768
    s_waitcnt lgkmcnt(10)
    v_mfma_f32_32x32x16_bf16 v[64:79], v[216:219], v[232:235], v[64:79]
    s_waitcnt lgkmcnt(8)
    v_mfma_f32_32x32x16_bf16 v[64:79], v[220:223], v[236:239], v[64:79]
    s_waitcnt lgkmcnt(6)
    v_mfma_f32_32x32x16_bf16 v[64:79], v[224:227], v[240:243], v[64:79]
    s_waitcnt lgkmcnt(4)
    v_mfma_f32_32x32x16_bf16 v[64:79], v[228:231], v[244:247], v[64:79]
    s_nop 11
    v_cvt_pk_bf16_f32 v192, v64, v65
    v_cvt_pk_bf16_f32 v193, v66, v67
    v_cvt_pk_bf16_f32 v194, v68, v69
    v_cvt_pk_bf16_f32 v195, v70, v71
    v_cvt_pk_bf16_f32 v196, v72, v73
    v_cvt_pk_bf16_f32 v197, v74, v75
    v_cvt_pk_bf16_f32 v198, v76, v77
    v_cvt_pk_bf16_f32 v199, v78, v79
    s_waitcnt lgkmcnt(0)
    v_mfma_f32_32x32x16_bf16 v[160:175], v[248:251], v[192:195], 0
    v_mfma_f32_32x32x16_bf16 v[176:191], v[252:255], v[196:199], 0
    s_load_dwordx2 s[16:17], s[0:1], 24
    s_load_dwordx2 s[20:21], s[0:1], 48
    s_load_dwordx2 s[24:25], s[0:1], 64
    s_mov_b32 s18, 0x80000
    s_mov_b32 s22, 0x80000
    s_mov_b32 s26, 0x200000
    v_mov_b64 v[120:121], v[30:31]
    v_mov_b64 v[122:123], v[30:31]
    v_mov_b64 v[124:125], v[30:31]
    v_mov_b64 v[126:127], v[30:31]
    v_mov_b64 v[128:129], v[30:31]
    v_mov_b64 v[130:131], v[30:31]
    v_mov_b64 v[132:133], v[30:31]
    v_mov_b64 v[134:135], v[30:31]
    s_and_b32 s5, s54, 0x8000
    v_mov_b32 v136, 0xdddddddd
    v_add_u32 v137, s5, v3
    s_add_u32 s5, s5, 65536
    v_and_b32 v138, 0x1ff, v25
    v_add_u32 v138, s5, v138
    v_and_b32 v139, 0x1f0, v3
    v_lshlrev_b32 v139, 3, v139
    v_mov_b32 v148, v7
    v_cvt_pk_bf16_f32 v200, v160, v161
    v_cvt_pk_bf16_f32 v201, v162, v163
    v_cvt_pk_bf16_f32 v202, v164, v165
    v_cvt_pk_bf16_f32 v203, v166, v167
    v_cvt_pk_bf16_f32 v204, v176, v177
    v_cvt_pk_bf16_f32 v205, v178, v179
    v_cvt_pk_bf16_f32 v206, v180, v181
    v_cvt_pk_bf16_f32 v207, v182, v183
    v_lshlrev_b32 v160, 16, v200
    v_and_b32 v161, 0xffff0000, v200
    v_lshlrev_b32 v162, 16, v201
    v_and_b32 v163, 0xffff0000, v201
    v_lshlrev_b32 v164, 16, v202
    v_and_b32 v165, 0xffff0000, v202
    v_lshlrev_b32 v166, 16, v203
    v_and_b32 v167, 0xffff0000, v203
    v_lshlrev_b32 v176, 16, v204
    v_and_b32 v177, 0xffff0000, v204
    v_lshlrev_b32 v178, 16, v205
    v_and_b32 v179, 0xffff0000, v205
    v_lshlrev_b32 v180, 16, v206
    v_and_b32 v181, 0xffff0000, v206
    v_lshlrev_b32 v182, 16, v207
    v_and_b32 v183, 0xffff0000, v207
    v_max3_f32 v200, v160, v161, v162
    v_max3_f32 v201, -v160, -v161, -v162
    v_max3_f32 v200, v200, v163, v164
    v_max3_f32 v201, v201, -v163, -v164
    v_max3_f32 v200, v200, v165, v166
    v_max3_f32 v201, v201, -v165, -v166
    v_max_f32 v200, v200, v167
    v_max_f32_e64 v201, v201, -v167
    v_max3_f32 v204, v176, v177, v178
    v_max3_f32 v205, -v176, -v177, -v178
    v_max3_f32 v204, v204, v179, v180
    v_max3_f32 v205, v205, -v179, -v180
    v_max3_f32 v204, v204, v181, v182
    v_max3_f32 v205, v205, -v181, -v182
    v_max_f32 v204, v204, v183
    v_max_f32_e64 v205, v205, -v183
    v_permlane32_swap_b32 v200, v201
    s_nop 0
    v_permlane32_swap_b32 v204, v205
    v_max_f32 v200, v200, v201
    v_max_f32 v204, v204, v205
    v_mul_f32 v200, 0xbfb8aa3b, v200
    v_mul_f32 v204, 0xbfb8aa3b, v204
    v_mov_b32 v201, v200
    v_mov_b32 v205, v204
    s_nop 0
    v_permlane32_swap_b32 v200, v201
    v_permlane32_swap_b32 v204, v205
    v_pk_fma_f32 v[64:65], v[160:161], s[10:11], v[200:201] op_sel_hi:[1,0,0]
    v_pk_fma_f32 v[72:73], v[160:161], s[10:11], v[200:201] op_sel:[0,0,1] op_sel_hi:[1,0,1] neg_lo:[1,0,0] neg_hi:[1,0,0]
    v_pk_fma_f32 v[66:67], v[162:163], s[10:11], v[200:201] op_sel_hi:[1,0,0]
    v_pk_fma_f32 v[74:75], v[162:163], s[10:11], v[200:201] op_sel:[0,0,1] op_sel_hi:[1,0,1] neg_lo:[1,0,0] neg_hi:[1,0,0]
    v_pk_fma_f32 v[68:69], v[164:165], s[10:11], v[200:201] op_sel_hi:[1,0,0]
    v_pk_fma_f32 v[76:77], v[164:165], s[10:11], v[200:201] op_sel:[0,0,1] op_sel_hi:[1,0,1] neg_lo:[1,0,0] neg_hi:[1,0,0]
    v_pk_fma_f32 v[70:71], v[166:167], s[10:11], v[200:201] op_sel_hi:[1,0,0]
    v_pk_fma_f32 v[78:79], v[166:167], s[10:11], v[200:201] op_sel:[0,0,1] op_sel_hi:[1,0,1] neg_lo:[1,0,0] neg_hi:[1,0,0]
    v_pk_fma_f32 v[80:81], v[176:177], s[10:11], v[204:205] op_sel_hi:[1,0,0]
    v_pk_fma_f32 v[88:89], v[176:177], s[10:11], v[204:205] op_sel:[0,0,1] op_sel_hi:[1,0,1] neg_lo:[1,0,0] neg_hi:[1,0,0]
    v_pk_fma_f32 v[82:83], v[178:179], s[10:11], v[204:205] op_sel_hi:[1,0,0]
    v_pk_fma_f32 v[90:91], v[178:179], s[10:11], v[204:205] op_sel:[0,0,1] op_sel_hi:[1,0,1] neg_lo:[1,0,0] neg_hi:[1,0,0]
    v_pk_fma_f32 v[84:85], v[180:181], s[10:11], v[204:205] op_sel_hi:[1,0,0]
    v_pk_fma_f32 v[92:93], v[180:181], s[10:11], v[204:205] op_sel:[0,0,1] op_sel_hi:[1,0,1] neg_lo:[1,0,0] neg_hi:[1,0,0]
    v_pk_fma_f32 v[86:87], v[182:183], s[10:11], v[204:205] op_sel_hi:[1,0,0]
    v_pk_fma_f32 v[94:95], v[182:183], s[10:11], v[204:205] op_sel:[0,0,1] op_sel_hi:[1,0,1] neg_lo:[1,0,0] neg_hi:[1,0,0]
    s_cmp_lg_u32 s3, 0
    s_cbranch_scc1 L_p2_np
    buffer_load_dword v0, v139, s[32:35], s49 offen sc1
L_p2_np:
    v_exp_f32 v64, v64
    v_exp_f32 v65, v65
    v_exp_f32 v66, v66
    v_exp_f32 v67, v67
    v_exp_f32 v68, v68
    v_exp_f32 v69, v69
    v_exp_f32 v70, v70
    v_exp_f32 v71, v71
    v_exp_f32 v72, v72
    v_exp_f32 v73, v73
    v_exp_f32 v74, v74
    v_exp_f32 v75, v75
    v_exp_f32 v76, v76
    v_exp_f32 v77, v77
    v_exp_f32 v78, v78
    v_exp_f32 v79, v79
    v_exp_f32 v80, v80
    v_exp_f32 v81, v81
    v_exp_f32 v82, v82
    v_exp_f32 v83, v83
    v_exp_f32 v84, v84
    v_exp_f32 v85, v85
    v_exp_f32 v86, v86
    v_exp_f32 v87, v87
    v_exp_f32 v88, v88
    v_exp_f32 v89, v89
    v_exp_f32 v90, v90
    v_exp_f32 v91, v91
    v_exp_f32 v92, v92
    v_exp_f32 v93, v93
    v_exp_f32 v94, v94
    v_exp_f32 v95, v95
    v_pk_add_f32 v[160:161], v[64:65], v[66:67]
    v_pk_add_f32 v[162:163], v[68:69], v[70:71]
    v_pk_add_f32 v[164:165], v[72:73], v[74:75]
    v_pk_add_f32 v[166:167], v[76:77], v[78:79]
    v_pk_add_f32 v[176:177], v[80:81], v[82:83]
    v_pk_add_f32 v[178:179], v[84:85], v[86:87]
    v_pk_add_f32 v[180:181], v[88:89], v[90:91]
    v_pk_add_f32 v[182:183], v[92:93], v[94:95]
    v_pk_add_f32 v[160:161], v[160:161], v[162:163]
    v_pk_add_f32 v[164:165], v[164:165], v[166:167]
    v_pk_add_f32 v[176:177], v[176:177], v[178:179]
    v_pk_add_f32 v[180:181], v[180:181], v[182:183]
    v_add_f32 v200, v160, v161
    v_add_f32 v201, v164, v165
    v_add_f32 v204, v176, v177
    v_add_f32 v205, v180, v181
    v_permlane32_swap_b32 v200, v201
    s_nop 0
    v_permlane32_swap_b32 v204, v205
    v_add_f32 v200, v200, v201
    v_add_f32 v204, v204, v205
    v_rcp_f32 v200, v200
    v_rcp_f32 v204, v204
    v_mov_b32 v201, v200
    v_mov_b32 v205, v204
    s_nop 0
    v_permlane32_swap_b32 v200, v201
    v_permlane32_swap_b32 v204, v205
    s_cmp_lg_u32 s3, 0
    s_cbranch_scc1 L_p2_go
    s_mov_b32 s7, 200000
    s_branch L_pollF1_chk
L_pollF1:
    buffer_load_dword v0, v139, s[32:35], s49 offen sc1
L_pollF1_chk:
    s_waitcnt vmcnt(0)
L_pollF1_cmp:
    v_cmp_ne_u32 s[44:45], s36, v0
    s_sub_u32 s7, s7, 1
    s_or_b32 s44, s44, s45
    s_and_b32 s44, s44, s68
    s_cbranch_scc0 L_pollF1_ok
    s_cmp_eq_u32 s7, 0
    s_cbranch_scc1 L_pollF1_ok
    s_sleep 1
    s_branch L_pollF1
L_pollF1_ok:
L_p2_go:
    s_barrier
    v_pk_mul_f32 v[64:65], v[64:65], v[200:201] op_sel_hi:[1,0]
    buffer_load_dwordx4 v[152:155], v3, s[32:35], s56 offen sc1
    v_pk_mul_f32 v[72:73], v[72:73], v[200:201] op_sel:[0,1]
    v_pk_mul_f32 v[66:67], v[66:67], v[200:201] op_sel_hi:[1,0]
    v_pk_mul_f32 v[74:75], v[74:75], v[200:201] op_sel:[0,1]
    v_pk_mul_f32 v[68:69], v[68:69], v[200:201] op_sel_hi:[1,0]
    v_pk_mul_f32 v[76:77], v[76:77], v[200:201] op_sel:[0,1]
    v_pk_mul_f32 v[70:71], v[70:71], v[200:201] op_sel_hi:[1,0]
    v_pk_mul_f32 v[78:79], v[78:79], v[200:201] op_sel:[0,1]
    v_pk_mul_f32 v[80:81], v[80:81], v[204:205] op_sel_hi:[1,0]
    buffer_load_dwordx4 v[8:11], v3, s[32:35], s58 offen sc1
    v_pk_mul_f32 v[88:89], v[88:89], v[204:205] op_sel:[0,1]
    v_pk_mul_f32 v[82:83], v[82:83], v[204:205] op_sel_hi:[1,0]
    v_pk_mul_f32 v[90:91], v[90:91], v[204:205] op_sel:[0,1]
    v_pk_mul_f32 v[84:85], v[84:85], v[204:205] op_sel_hi:[1,0]
    v_pk_mul_f32 v[92:93], v[92:93], v[204:205] op_sel:[0,1]
    v_pk_mul_f32 v[86:87], v[86:87], v[204:205] op_sel_hi:[1,0]
    v_pk_mul_f32 v[94:95], v[94:95], v[204:205] op_sel:[0,1]
    v_cvt_pk_bf16_f32 v232, v64, v65
    buffer_load_dwordx4 v[12:15], v3, s[32:35], s57 offen sc1
    v_cvt_pk_bf16_f32 v233, v66, v67
    v_cvt_pk_bf16_f32 v234, v68, v69
    v_cvt_pk_bf16_f32 v235, v70, v71
    v_cvt_pk_bf16_f32 v236, v72, v73
    v_cvt_pk_bf16_f32 v237, v74, v75
    v_cvt_pk_bf16_f32 v238, v76, v77
    v_cvt_pk_bf16_f32 v239, v78, v79
    v_cvt_pk_bf16_f32 v240, v80, v81
    s_add_u32 m0, s54, 0
    s_add_u32 s4, s55, 0
    buffer_load_dwordx4 v3, s[32:35], s4 offen sc1 lds
    v_cvt_pk_bf16_f32 v241, v82, v83
    v_cvt_pk_bf16_f32 v242, v84, v85
    v_cvt_pk_bf16_f32 v243, v86, v87
    v_cvt_pk_bf16_f32 v244, v88, v89
    v_cvt_pk_bf16_f32 v245, v90, v91
    v_cvt_pk_bf16_f32 v246, v92, v93
    v_cvt_pk_bf16_f32 v247, v94, v95
    s_add_u32 m0, s54, 65536
    s_add_u32 s4, s55, 2097152
    buffer_load_dwordx4 v3, s[32:35], s4 offen sc1 lds
    s_waitcnt vmcnt(5)
    s_cmp_eq_u32 s42, 0
    s_cbranch_scc0 L_skip_t0
    v_mfma_f32_32x32x16_bf16 v[160:175], v[232:235], v[56:59], 0
    v_mfma_f32_32x32x16_bf16 v[160:175], v[236:239], v[60:63], v[160:175]
    v_mfma_f32_32x32x16_bf16 v[176:191], v[240:243], v[56:59], 0
    v_mfma_f32_32x32x16_bf16 v[176:191], v[244:247], v[60:63], v[176:191]
    s_nop 9
    v_cvt_pk_bf16_f32 v192, v160, v161
    v_cvt_pk_bf16_f32 v193, v162, v163
    v_cvt_pk_bf16_f32 v194, v164, v165
    v_cvt_pk_bf16_f32 v195, v166, v167
    v_cvt_pk_bf16_f32 v196, v168, v169
    v_cvt_pk_bf16_f32 v197, v170, v171
    v_cvt_pk_bf16_f32 v198, v172, v173
    v_cvt_pk_bf16_f32 v199, v174, v175
    v_mfma_f32_32x32x16_bf16 v[64:79], v[192:195], v[96:99], 0
    s_nop 0
    v_mfma_f32_32x32x16_bf16 v[64:79], v[196:199], v[100:103], v[64:79]
    v_cvt_pk_bf16_f32 v200, v176, v177
    v_cvt_pk_bf16_f32 v201, v178, v179
    v_cvt_pk_bf16_f32 v202, v180, v181
    v_cvt_pk_bf16_f32 v203, v182, v183
    v_cvt_pk_bf16_f32 v204, v184, v185
    v_cvt_pk_bf16_f32 v205, v186, v187
    v_cvt_pk_bf16_f32 v206, v188, v189
    v_cvt_pk_bf16_f32 v207, v190, v191
    v_mfma_f32_32x32x16_bf16 v[80:95], v[200:203], v[104:107], 0
    s_nop 0
    v_mfma_f32_32x32x16_bf16 v[80:95], v[204:207], v[108:111], v[80:95]
    s_nop 0
    ds_write_b128 v26, v[64:67] offset:0
    ds_write_b128 v26, v[68:71] offset:1024
    ds_write_b128 v26, v[72:75] offset:2048
    ds_write_b128 v26, v[76:79] offset:3072
    s_nop 6
    ds_write_b128 v26, v[80:83] offset:4096
    ds_write_b128 v26, v[84:87] offset:5120
    ds_write_b128 v26, v[88:91] offset:6144
    ds_write_b128 v26, v[92:95] offset:7168
    s_branch L_p1_done
L_skip_t0:
    v_lshlrev_b32 v56, 16, v96
    v_lshlrev_b32 v58, 16, v104
    v_and_b32 v57, 0xffff0000, v96
    v_and_b32 v59, 0xffff0000, v104
    v_pk_mul_f32 v[56:57], v[56:57], v[58:59]
    v_cvt_pk_bf16_f32 v58, v56, v57
    v_lshlrev_b32 v52, 16, v58
    v_and_b32 v53, 0xffff0000, v58
    v_lshlrev_b32 v60, 16, v97
    v_lshlrev_b32 v62, 16, v105
    v_and_b32 v61, 0xffff0000, v97
    v_and_b32 v63, 0xffff0000, v105
    v_pk_mul_f32 v[60:61], v[60:61], v[62:63]
    v_cvt_pk_bf16_f32 v62, v60, v61
    v_lshlrev_b32 v60, 16, v62
    v_and_b32 v61, 0xffff0000, v62
    v_pk_add_f32 v[52:53], v[52:53], v[60:61]
    v_lshlrev_b32 v56, 16, v98
    v_lshlrev_b32 v58, 16, v106
    v_and_b32 v57, 0xffff0000, v98
    v_and_b32 v59, 0xffff0000, v106
    v_pk_mul_f32 v[56:57], v[56:57], v[58:59]
    v_cvt_pk_bf16_f32 v58, v56, v57
    v_lshlrev_b32 v56, 16, v58
    v_and_b32 v57, 0xffff0000, v58
    v_pk_add_f32 v[52:53], v[52:53], v[56:57]
    v_lshlrev_b32 v60, 16, v99
    v_lshlrev_b32 v62, 16, v107
    v_and_b32 v61, 0xffff0000, v99
    v_and_b32 v63, 0xffff0000, v107
    v_pk_mul_f32 v[60:61], v[60:61], v[62:63]
    v_cvt_pk_bf16_f32 v62, v60, v61
    v_lshlrev_b32 v60, 16, v62
    v_and_b32 v61, 0xffff0000, v62
    v_pk_add_f32 v[52:53], v[52:53], v[60:61]
    v_lshlrev_b32 v56, 16, v100
    v_lshlrev_b32 v58, 16, v108
    v_and_b32 v57, 0xffff0000, v100
    v_and_b32 v59, 0xffff0000, v108
    v_pk_mul_f32 v[56:57], v[56:57], v[58:59]
    v_cvt_pk_bf16_f32 v58, v56, v57
    v_lshlrev_b32 v56, 16, v58
    v_and_b32 v57, 0xffff0000, v58
    v_pk_add_f32 v[52:53], v[52:53], v[56:57]
    v_lshlrev_b32 v60, 16, v101
    v_lshlrev_b32 v62, 16, v109
    v_and_b32 v61, 0xffff0000, v101
    v_and_b32 v63, 0xffff0000, v109
    v_pk_mul_f32 v[60:61], v[60:61], v[62:63]
    v_cvt_pk_bf16_f32 v62, v60, v61
    v_lshlrev_b32 v60, 16, v62
    v_and_b32 v61, 0xffff0000, v62
    v_pk_add_f32 v[52:53], v[52:53], v[60:61]
    v_lshlrev_b32 v56, 16, v102
    v_lshlrev_b32 v58, 16, v110
    v_and_b32 v57, 0xffff0000, v102
    v_and_b32 v59, 0xffff0000, v110
    v_pk_mul_f32 v[56:57], v[56:57], v[58:59]
    v_cvt_pk_bf16_f32 v58, v56, v57
    v_lshlrev_b32 v56, 16, v58
    v_and_b32 v57, 0xffff0000, v58
    v_pk_add_f32 v[52:53], v[52:53], v[56:57]
    v_lshlrev_b32 v60, 16, v103
    v_lshlrev_b32 v62, 16, v111
    v_and_b32 v61, 0xffff0000, v103
    v_and_b32 v63, 0xffff0000, v111
    v_pk_mul_f32 v[60:61], v[60:61], v[62:63]
    v_cvt_pk_bf16_f32 v62, v60, v61
    v_lshlrev_b32 v60, 16, v62
    v_and_b32 v61, 0xffff0000, v62
    v_pk_add_f32 v[52:53], v[52:53], v[60:61]
    v_add_f32 v52, v52, v53
    v_mov_b32 v53, v52
    v_lshrrev_b32 v6, 3, v1
    s_nop 0
    v_permlane16_swap_b32 v52, v53
    v_add_f32 v52, v52, v53
    s_nop 1
    v_add_f32_dpp v52, v52, v52 row_ror:8 row_mask:0xf bank_mask:0xf
    s_nop 1
    v_add_f32_dpp v52, v52, v52 row_ror:4 row_mask:0xf bank_mask:0xf
    s_nop 1
    v_add_f32_dpp v52, v52, v52 row_ror:2 row_mask:0xf bank_mask:0xf
    s_nop 1
    v_add_f32_dpp v52, v52, v52 row_ror:1 row_mask:0xf bank_mask:0xf
    v_cvt_pk_bf16_f32 v52, v52, v52
    v_lshlrev_b32 v52, 16, v52
    v_mul_f32 v52, 0xbfb8aa3b, v52
    v_exp_f32 v52, v52
    s_nop 0
    v_add_f32 v52, 1.0, v52
    v_rcp_f32 v52, v52
    s_nop 0
    v_cvt_pk_bf16_f32 v52, v52, v52
    v_lshlrev_b32 v52, 16, v52
L_p1_done:
    v_mov_b32 v5, 155648
    v_mov_b32 v7, 0
    v_mov_b64 v[196:197], 0
    v_mov_b64 v[198:199], 0
    s_waitcnt vmcnt(2)
    v_mfma_f32_32x32x16_bf16 v[200:215], v[152:155], v[8:11], 0
    v_mfma_f32_32x32x16_bf16 v[216:231], v[152:155], v[12:15], 0
    v_mov_b64 v[156:157], v[28:29]
    v_mov_b32 v158, v27
    s_mov_b64 exec, 1
    ds_write_b32 v5, v7
    s_mov_b64 exec, -1
    s_waitcnt lgkmcnt(0)
    v_mfma_f32_32x32x16_bf16 v[80:95], v[196:199], v[196:199], 0
    v_mfma_f32_32x32x16_bf16 v[96:111], v[196:199], v[196:199], 0
    s_nop 2
    v_max3_f32 v150, v200, v201, v202
    v_max3_f32 v150, v150, v203, v204
    v_max3_f32 v150, v150, v205, v206
    v_max3_f32 v150, v150, v207, v208
    v_max3_f32 v150, v150, v209, v210
    v_max3_f32 v150, v150, v211, v212
    v_max3_f32 v150, v150, v213, v214
    v_max_f32 v150, v150, v215
    v_max3_f32 v151, v216, v217, v218
    v_max3_f32 v151, v151, v219, v220
    v_max3_f32 v151, v151, v221, v222
    v_max3_f32 v151, v151, v223, v224
    v_max3_f32 v151, v151, v225, v226
    v_max3_f32 v151, v151, v227, v228
    v_max3_f32 v151, v151, v229, v230
    v_max_f32 v151, v151, v231
    s_nop 1
    v_permlane32_swap_b32 v150, v151
    v_max_f32 v150, v150, v151
    v_sub_f32 v150, 0, v150
    v_mov_b32 v151, v150
    s_nop 1
    v_permlane32_swap_b32 v150, v151
    v_pk_mov_b32 v[16:17], v[150:151], v[150:151] op_sel:[0,0]
    v_pk_mov_b32 v[18:19], v[150:151], v[150:151] op_sel:[0,0]
    v_pk_mov_b32 v[20:21], v[150:151], v[150:151] op_sel:[0,0]
    v_pk_mov_b32 v[22:23], v[150:151], v[150:151] op_sel:[0,0]
    v_pk_mov_b32 v[24:25], v[150:151], v[150:151] op_sel:[0,0]
    v_pk_mov_b32 v[26:27], v[150:151], v[150:151] op_sel:[0,0]
    v_pk_mov_b32 v[28:29], v[150:151], v[150:151] op_sel:[0,0]
    v_pk_mov_b32 v[30:31], v[150:151], v[150:151] op_sel:[0,0]
    v_pk_mov_b32 v[32:33], v[150:151], v[150:151] op_sel:[1,1]
    v_pk_mov_b32 v[34:35], v[150:151], v[150:151] op_sel:[1,1]
    v_pk_mov_b32 v[36:37], v[150:151], v[150:151] op_sel:[1,1]
    v_pk_mov_b32 v[38:39], v[150:151], v[150:151] op_sel:[1,1]
    v_pk_mov_b32 v[40:41], v[150:151], v[150:151] op_sel:[1,1]
    v_pk_mov_b32 v[42:43], v[150:151], v[150:151] op_sel:[1,1]
    v_pk_mov_b32 v[44:45], v[150:151], v[150:151] op_sel:[1,1]
    v_pk_mov_b32 v[46:47], v[150:151], v[150:151] op_sel:[1,1]
    s_cmp_eq_u32 s42, 0
    s_waitcnt vmcnt(0)
    s_barrier
    ds_read_b128 v[112:115], v137
    ds_read_b128 v[116:119], v137 offset:1024
    s_mov_b64 exec, s[14:15]
    ds_read_b128 v[120:123], v138
    ds_read_b128 v[124:127], v138 offset:512
    s_mov_b64 exec, -1
    s_cbranch_scc0 L_skip_r0
    ds_read_b128 v[160:163], v158 offset:0
    ds_read_b128 v[164:167], v158 offset:1024
    ds_read_b128 v[168:171], v158 offset:8192
    ds_read_b128 v[172:175], v158 offset:9216
    ds_read_b128 v[176:179], v158 offset:32768
    ds_read_b128 v[180:183], v158 offset:33792
    ds_read_b128 v[184:187], v158 offset:40960
    ds_read_b128 v[188:191], v158 offset:41984
    s_waitcnt lgkmcnt(11)
    s_branch L_first
L_skip_r0:
    s_mov_b32 exec_lo, 1
    s_mov_b32 exec_hi, 1
    buffer_store_dword v52, v6, s[32:35], s72 offen sc1
    s_mov_b64 exec, -1
L_redo:
    s_waitcnt lgkmcnt(3)
L_first:
    v_mfma_f32_32x32x16_bf16 v[48:63], v[112:115], v[8:11], v[16:31]
    v_mfma_f32_32x32x16_bf16 v[64:79], v[112:115], v[12:15], v[32:47]
    s_add_u32 m0, s54, 4096
    s_add_u32 s4, s55, 4096
    buffer_load_dwordx4 v3, s[32:35], s4 offen sc1 lds
    s_add_u32 m0, s54, 69632
    s_add_u32 s4, s55, 2101248
    buffer_load_dwordx4 v3, s[32:35], s4 offen sc1 lds
    s_nop 4
    v_exp_f32 v48, v48
    v_exp_f32 v49, v49
    v_exp_f32 v50, v50
    v_exp_f32 v51, v51
    v_exp_f32 v52, v52
    v_exp_f32 v53, v53
    v_exp_f32 v54, v54
    s_waitcnt lgkmcnt(0)
    v_mfma_f32_32x32x16_bf16 v[200:215], v[116:119], v[8:11], v[16:31]
    s_bitcmp1_b32 s59, 0
    s_cbranch_scc0 L_skip_kp
    v_pk_add_f32 v[160:161], v[160:161], v[168:169]
    v_pk_add_f32 v[162:163], v[162:163], v[170:171]
    v_pk_add_f32 v[164:165], v[164:165], v[172:173]
    v_pk_add_f32 v[166:167], v[166:167], v[174:175]
    v_pk_add_f32 v[176:177], v[176:177], v[184:185]
    v_pk_add_f32 v[178:179], v[178:179], v[186:187]
    v_pk_add_f32 v[180:181], v[180:181], v[188:189]
    v_pk_add_f32 v[182:183], v[182:183], v[190:191]
    v_pk_add_f32 v[160:161], v[160:161], v[176:177]
    v_pk_add_f32 v[162:163], v[162:163], v[178:179]
    v_pk_add_f32 v[164:165], v[164:165], v[180:181]
    v_pk_add_f32 v[166:167], v[166:167], v[182:183]
    buffer_store_dwordx4 v[160:163], v156, s[32:35], s60 offen sc1
    buffer_store_dwordx4 v[164:167], v157, s[32:35], s60 offen sc1
L_skip_kp:
    v_exp_f32 v55, v55
    v_exp_f32 v56, v56
    v_exp_f32 v57, v57
    v_exp_f32 v58, v58
    v_exp_f32 v59, v59
    v_smfmac_f32_32x32x32_bf16 v[80:95], v[120:123], v[48:55], v136
    ds_read_b128 v[112:115], v137 offset:2048
    v_exp_f32 v60, v60
    v_exp_f32 v61, v61
    v_exp_f32 v62, v62
    v_exp_f32 v63, v63
    s_setprio 1
    v_exp_f32 v64, v64
    v_exp_f32 v65, v65
    v_smfmac_f32_32x32x32_bf16 v[80:95], v[124:127], v[56:63], v136
    v_exp_f32 v66, v66
    v_exp_f32 v67, v67
    v_exp_f32 v68, v68
    v_exp_f32 v69, v69
    v_exp_f32 v70, v70
    v_mfma_f32_32x32x16_bf16 v[216:231], v[116:119], v[12:15], v[32:47]
    v_exp_f32 v71, v71
    v_exp_f32 v72, v72
    v_exp_f32 v73, v73
    v_exp_f32 v74, v74
    v_exp_f32 v75, v75
    v_smfmac_f32_32x32x32_bf16 v[96:111], v[120:123], v[64:71], v136
    s_mov_b64 exec, s[14:15]
    ds_read_b128 v[128:131], v138 offset:1024
    ds_read_b128 v[132:135], v138 offset:1536
    s_mov_b64 exec, -1
    v_exp_f32 v76, v76
    v_exp_f32 v77, v77
    v_exp_f32 v78, v78
    v_exp_f32 v79, v79
    v_exp_f32 v200, v200
    v_exp_f32 v201, v201
    v_smfmac_f32_32x32x32_bf16 v[96:111], v[124:127], v[72:79], v136
    v_exp_f32 v202, v202
    v_exp_f32 v203, v203
    v_exp_f32 v204, v204
    v_exp_f32 v205, v205
    v_exp_f32 v206, v206
    s_waitcnt lgkmcnt(0)
    v_mfma_f32_32x32x16_bf16 v[48:63], v[112:115], v[8:11], v[16:31]
    v_exp_f32 v207, v207
    v_exp_f32 v208, v208
    v_exp_f32 v209, v209
    v_exp_f32 v210, v210
    v_exp_f32 v211, v211
    v_smfmac_f32_32x32x32_bf16 v[80:95], v[128:131], v[200:207], v136
    ds_read_b128 v[116:119], v137 offset:3072
    v_exp_f32 v212, v212
    v_exp_f32 v213, v213
    v_exp_f32 v214, v214
    v_exp_f32 v215, v215
    s_setprio 0
    v_exp_f32 v216, v216
    v_exp_f32 v217, v217
    v_smfmac_f32_32x32x32_bf16 v[80:95], v[132:135], v[208:215], v136
    v_exp_f32 v218, v218
    v_exp_f32 v219, v219
    v_exp_f32 v220, v220
    v_exp_f32 v221, v221
    v_exp_f32 v222, v222
    v_mfma_f32_32x32x16_bf16 v[64:79], v[112:115], v[12:15], v[32:47]
    v_exp_f32 v223, v223
    v_exp_f32 v224, v224
    v_exp_f32 v225, v225
    v_exp_f32 v226, v226
    v_exp_f32 v227, v227
    v_smfmac_f32_32x32x32_bf16 v[96:111], v[128:131], v[216:223], v136
    s_mov_b64 exec, s[14:15]
    ds_read_b128 v[120:123], v138 offset:2048
    ds_read_b128 v[124:127], v138 offset:2560
    s_mov_b64 exec, -1
    v_exp_f32 v228, v228
    v_exp_f32 v229, v229
    v_exp_f32 v230, v230
    v_exp_f32 v231, v231
    v_exp_f32 v48, v48
    v_exp_f32 v49, v49
    v_smfmac_f32_32x32x32_bf16 v[96:111], v[132:135], v[224:231], v136
    s_waitcnt vmcnt(0)
    s_barrier
    s_bitcmp1_b32 s59, 1
    s_cbranch_scc1 L_job_f2
L_ret_f2:
    v_exp_f32 v50, v50
    v_exp_f32 v51, v51
    v_exp_f32 v52, v52
    v_exp_f32 v53, v53
    v_exp_f32 v54, v54
    s_waitcnt lgkmcnt(0)
    v_mfma_f32_32x32x16_bf16 v[200:215], v[116:119], v[8:11], v[16:31]
    v_exp_f32 v55, v55
    v_exp_f32 v56, v56
    v_exp_f32 v57, v57
    v_exp_f32 v58, v58
    v_exp_f32 v59, v59
    v_smfmac_f32_32x32x32_bf16 v[80:95], v[120:123], v[48:55], v136
    ds_read_b128 v[112:115], v137 offset:4096
    v_exp_f32 v60, v60
    v_exp_f32 v61, v61
    v_exp_f32 v62, v62
    v_exp_f32 v63, v63
    s_setprio 3
    v_exp_f32 v64, v64
    v_exp_f32 v65, v65
    v_smfmac_f32_32x32x32_bf16 v[80:95], v[124:127], v[56:63], v136
    v_exp_f32 v66, v66
    v_exp_f32 v67, v67
    v_exp_f32 v68, v68
    v_exp_f32 v69, v69
    v_exp_f32 v70, v70
    v_mfma_f32_32x32x16_bf16 v[216:231], v[116:119], v[12:15], v[32:47]
    s_bitcmp1_b32 s59, 5
    s_cbranch_scc0 L_skip_tb6
    global_load_dwordx4 v[140:143], v148, s[46:47] offset:2048
L_skip_tb6:
    s_bitcmp1_b32 s59, 5
    s_cbranch_scc0 L_skip_tb7
    global_load_dwordx4 v[144:147], v148, s[46:47] offset:3072
L_skip_tb7:
    v_exp_f32 v71, v71
    v_exp_f32 v72, v72
    v_exp_f32 v73, v73
    v_exp_f32 v74, v74
    v_exp_f32 v75, v75
    v_smfmac_f32_32x32x32_bf16 v[96:111], v[120:123], v[64:71], v136
    s_mov_b64 exec, s[14:15]
    ds_read_b128 v[128:131], v138 offset:3072
    ds_read_b128 v[132:135], v138 offset:3584
    s_mov_b64 exec, -1
    v_exp_f32 v76, v76
    v_exp_f32 v77, v77
    v_exp_f32 v78, v78
    v_exp_f32 v79, v79
    v_exp_f32 v200, v200
    v_exp_f32 v201, v201
    v_smfmac_f32_32x32x32_bf16 v[96:111], v[124:127], v[72:79], v136
    s_add_u32 m0, s54, 8192
    s_add_u32 s4, s55, 8192
    buffer_load_dwordx4 v3, s[32:35], s4 offen sc1 lds
    v_exp_f32 v202, v202
    v_exp_f32 v203, v203
    v_exp_f32 v204, v204
    v_exp_f32 v205, v205
    v_exp_f32 v206, v206
    s_waitcnt lgkmcnt(0)
    v_mfma_f32_32x32x16_bf16 v[48:63], v[112:115], v[8:11], v[16:31]
    v_exp_f32 v207, v207
    v_exp_f32 v208, v208
    v_exp_f32 v209, v209
    v_exp_f32 v210, v210
    v_exp_f32 v211, v211
    v_smfmac_f32_32x32x32_bf16 v[80:95], v[128:131], v[200:207], v136
    ds_read_b128 v[116:119], v137 offset:5120
    v_exp_f32 v212, v212
    v_exp_f32 v213, v213
    v_exp_f32 v214, v214
    v_exp_f32 v215, v215
    s_setprio 2
    v_exp_f32 v216, v216
    v_exp_f32 v217, v217
    v_smfmac_f32_32x32x32_bf16 v[80:95], v[132:135], v[208:215], v136
    s_add_u32 m0, s54, 73728
    s_add_u32 s4, s55, 2105344
    buffer_load_dwordx4 v3, s[32:35], s4 offen sc1 lds
    v_exp_f32 v218, v218
    v_exp_f32 v219, v219
    v_exp_f32 v220, v220
    v_exp_f32 v221, v221
    v_exp_f32 v222, v222
    v_mfma_f32_32x32x16_bf16 v[64:79], v[112:115], v[12:15], v[32:47]
    v_exp_f32 v223, v223
    v_exp_f32 v224, v224
    v_exp_f32 v225, v225
    v_exp_f32 v226, v226
    v_exp_f32 v227, v227
    v_smfmac_f32_32x32x32_bf16 v[96:111], v[128:131], v[216:223], v136
    s_mov_b64 exec, s[14:15]
    ds_read_b128 v[120:123], v138 offset:4096
    ds_read_b128 v[124:127], v138 offset:4608
    s_mov_b64 exec, -1
    v_exp_f32 v228, v228
    v_exp_f32 v229, v229
    v_exp_f32 v230, v230
    v_exp_f32 v231, v231
    v_exp_f32 v48, v48
    v_exp_f32 v49, v49
    v_smfmac_f32_32x32x32_bf16 v[96:111], v[132:135], v[224:231], v136
    s_add_u32 m0, s54, 12288
    s_add_u32 s4, s55, 12288
    buffer_load_dwordx4 v3, s[32:35], s4 offen sc1 lds
    v_exp_f32 v50, v50
    v_exp_f32 v51, v51
    v_exp_f32 v52, v52
    v_exp_f32 v53, v53
    v_exp_f32 v54, v54
    s_waitcnt lgkmcnt(0)
    v_mfma_f32_32x32x16_bf16 v[200:215], v[116:119], v[8:11], v[16:31]
    v_exp_f32 v55, v55
    v_exp_f32 v56, v56
    v_exp_f32 v57, v57
    v_exp_f32 v58, v58
    v_exp_f32 v59, v59
    v_smfmac_f32_32x32x32_bf16 v[80:95], v[120:123], v[48:55], v136
    ds_read_b128 v[112:115], v137 offset:6144
    v_exp_f32 v60, v60
    v_exp_f32 v61, v61
    v_exp_f32 v62, v62
    v_exp_f32 v63, v63
    s_setprio 1
    v_exp_f32 v64, v64
    v_exp_f32 v65, v65
    v_smfmac_f32_32x32x32_bf16 v[80:95], v[124:127], v[56:63], v136
    s_add_u32 m0, s54, 77824
    s_add_u32 s4, s55, 2109440
    buffer_load_dwordx4 v3, s[32:35], s4 offen sc1 lds
    v_exp_f32 v66, v66
    v_exp_f32 v67, v67
    v_exp_f32 v68, v68
    v_exp_f32 v69, v69
    v_exp_f32 v70, v70
    v_mfma_f32_32x32x16_bf16 v[216:231], v[116:119], v[12:15], v[32:47]
    v_exp_f32 v71, v71
    v_exp_f32 v72, v72
    v_exp_f32 v73, v73
    v_exp_f32 v74, v74
    v_exp_f32 v75, v75
    v_smfmac_f32_32x32x32_bf16 v[96:111], v[120:123], v[64:71], v136
    s_mov_b64 exec, s[14:15]
    ds_read_b128 v[128:131], v138 offset:5120
    ds_read_b128 v[132:135], v138 offset:5632
    s_mov_b64 exec, -1
    v_exp_f32 v76, v76
    v_exp_f32 v77, v77
    v_exp_f32 v78, v78
    v_exp_f32 v79, v79
    v_exp_f32 v200, v200
    v_exp_f32 v201, v201
    v_smfmac_f32_32x32x32_bf16 v[96:111], v[124:127], v[72:79], v136
    v_exp_f32 v202, v202
    v_exp_f32 v203, v203
    v_exp_f32 v204, v204
    v_exp_f32 v205, v205
    v_exp_f32 v206, v206
    s_waitcnt lgkmcnt(0)
    v_mfma_f32_32x32x16_bf16 v[48:63], v[112:115], v[8:11], v[16:31]
    s_bitcmp1_b32 s59, 2
    s_cbranch_scc1 L_job_p2
L_ret_p2:
    v_exp_f32 v207, v207
    v_exp_f32 v208, v208
    v_exp_f32 v209, v209
    v_exp_f32 v210, v210
    v_exp_f32 v211, v211
    v_smfmac_f32_32x32x32_bf16 v[80:95], v[128:131], v[200:207], v136
    ds_read_b128 v[116:119], v137 offset:7168
    v_exp_f32 v212, v212
    v_exp_f32 v213, v213
    v_exp_f32 v214, v214
    v_exp_f32 v215, v215
    s_setprio 0
    v_exp_f32 v216, v216
    v_exp_f32 v217, v217
    v_smfmac_f32_32x32x32_bf16 v[80:95], v[132:135], v[208:215], v136
    v_exp_f32 v218, v218
    v_exp_f32 v219, v219
    v_exp_f32 v220, v220
    v_exp_f32 v221, v221
    v_exp_f32 v222, v222
    v_mfma_f32_32x32x16_bf16 v[64:79], v[112:115], v[12:15], v[32:47]
    v_exp_f32 v223, v223
    v_exp_f32 v224, v224
    v_exp_f32 v225, v225
    v_exp_f32 v226, v226
    v_exp_f32 v227, v227
    v_smfmac_f32_32x32x32_bf16 v[96:111], v[128:131], v[216:223], v136
    s_mov_b64 exec, s[14:15]
    ds_read_b128 v[120:123], v138 offset:6144
    ds_read_b128 v[124:127], v138 offset:6656
    s_mov_b64 exec, -1
    v_exp_f32 v228, v228
    v_exp_f32 v229, v229
    v_exp_f32 v230, v230
    v_exp_f32 v231, v231
    v_exp_f32 v48, v48
    v_exp_f32 v49, v49
    v_smfmac_f32_32x32x32_bf16 v[96:111], v[132:135], v[224:231], v136
    s_waitcnt vmcnt(2)
    s_barrier
    v_exp_f32 v50, v50
    v_exp_f32 v51, v51
    v_exp_f32 v52, v52
    v_exp_f32 v53, v53
    v_exp_f32 v54, v54
    s_waitcnt lgkmcnt(0)
    v_mfma_f32_32x32x16_bf16 v[200:215], v[116:119], v[8:11], v[16:31]
    v_exp_f32 v55, v55
    v_exp_f32 v56, v56
    v_exp_f32 v57, v57
    v_exp_f32 v58, v58
    v_exp_f32 v59, v59
    v_smfmac_f32_32x32x32_bf16 v[80:95], v[120:123], v[48:55], v136
    ds_read_b128 v[112:115], v137 offset:8192
    v_exp_f32 v60, v60
    v_exp_f32 v61, v61
    v_exp_f32 v62, v62
    v_exp_f32 v63, v63
    s_setprio 3
    v_exp_f32 v64, v64
    v_exp_f32 v65, v65
    v_smfmac_f32_32x32x32_bf16 v[80:95], v[124:127], v[56:63], v136
    v_exp_f32 v66, v66
    v_exp_f32 v67, v67
    v_exp_f32 v68, v68
    v_exp_f32 v69, v69
    v_exp_f32 v70, v70
    v_mfma_f32_32x32x16_bf16 v[216:231], v[116:119], v[12:15], v[32:47]
    v_exp_f32 v71, v71
    v_exp_f32 v72, v72
    v_exp_f32 v73, v73
    v_exp_f32 v74, v74
    v_exp_f32 v75, v75
    v_smfmac_f32_32x32x32_bf16 v[96:111], v[120:123], v[64:71], v136
    s_mov_b64 exec, s[14:15]
    ds_read_b128 v[128:131], v138 offset:7168
    ds_read_b128 v[132:135], v138 offset:7680
    s_mov_b64 exec, -1
    v_exp_f32 v76, v76
    v_exp_f32 v77, v77
    v_exp_f32 v78, v78
    v_exp_f32 v79, v79
    v_exp_f32 v200, v200
    v_exp_f32 v201, v201
    v_smfmac_f32_32x32x32_bf16 v[96:111], v[124:127], v[72:79], v136
    s_add_u32 m0, s54, 0
    s_add_u32 s4, s65, 0
    buffer_load_dwordx4 v140, s[16:19], s4 offen lds
    v_exp_f32 v202, v202
    v_exp_f32 v203, v203
    v_exp_f32 v204, v204
    v_exp_f32 v205, v205
    v_exp_f32 v206, v206
    s_waitcnt lgkmcnt(0)
    v_mfma_f32_32x32x16_bf16 v[48:63], v[112:115], v[8:11], v[16:31]
    s_bitcmp1_b32 s59, 2
    s_cbranch_scc1 L_job_ld
L_ret_ld:
    v_exp_f32 v207, v207
    v_exp_f32 v208, v208
    v_exp_f32 v209, v209
    v_exp_f32 v210, v210
    v_exp_f32 v211, v211
    v_smfmac_f32_32x32x32_bf16 v[80:95], v[128:131], v[200:207], v136
    ds_read_b128 v[116:119], v137 offset:9216
    v_exp_f32 v212, v212
    v_exp_f32 v213, v213
    v_exp_f32 v214, v214
    v_exp_f32 v215, v215
    s_setprio 2
    v_exp_f32 v216, v216
    v_exp_f32 v217, v217
    v_smfmac_f32_32x32x32_bf16 v[80:95], v[132:135], v[208:215], v136
    s_add_u32 m0, s54, 65536
    s_add_u32 s4, s65, 262144
    buffer_load_dwordx4 v140, s[16:19], s4 offen lds
    v_exp_f32 v218, v218
    v_exp_f32 v219, v219
    v_exp_f32 v220, v220
    v_exp_f32 v221, v221
    v_exp_f32 v222, v222
    v_mfma_f32_32x32x16_bf16 v[64:79], v[112:115], v[12:15], v[32:47]
    v_exp_f32 v223, v223
    v_exp_f32 v224, v224
    v_exp_f32 v225, v225
    v_exp_f32 v226, v226
    v_exp_f32 v227, v227
    v_smfmac_f32_32x32x32_bf16 v[96:111], v[128:131], v[216:223], v136
    s_mov_b64 exec, s[14:15]
    ds_read_b128 v[120:123], v138 offset:8192
    ds_read_b128 v[124:127], v138 offset:8704
    s_mov_b64 exec, -1
    v_exp_f32 v228, v228
    v_exp_f32 v229, v229
    v_exp_f32 v230, v230
    v_exp_f32 v231, v231
    v_exp_f32 v48, v48
    v_exp_f32 v49, v49
    v_smfmac_f32_32x32x32_bf16 v[96:111], v[132:135], v[224:231], v136
    s_add_u32 m0, s54, 16384
    s_add_u32 s4, s55, 16384
    buffer_load_dwordx4 v3, s[32:35], s4 offen sc1 lds
    v_exp_f32 v50, v50
    v_exp_f32 v51, v51
    v_exp_f32 v52, v52
    v_exp_f32 v53, v53
    v_exp_f32 v54, v54
    s_waitcnt lgkmcnt(0)
    v_mfma_f32_32x32x16_bf16 v[200:215], v[116:119], v[8:11], v[16:31]
    v_exp_f32 v55, v55
    v_exp_f32 v56, v56
    v_exp_f32 v57, v57
    v_exp_f32 v58, v58
    v_exp_f32 v59, v59
    v_smfmac_f32_32x32x32_bf16 v[80:95], v[120:123], v[48:55], v136
    ds_read_b128 v[112:115], v137 offset:10240
    v_exp_f32 v60, v60
    v_exp_f32 v61, v61
    v_exp_f32 v62, v62
    v_exp_f32 v63, v63
    s_setprio 1
    v_exp_f32 v64, v64
    v_exp_f32 v65, v65
    v_smfmac_f32_32x32x32_bf16 v[80:95], v[124:127], v[56:63], v136
    s_add_u32 m0, s54, 81920
    s_add_u32 s4, s55, 2113536
    buffer_load_dwordx4 v3, s[32:35], s4 offen sc1 lds
    v_exp_f32 v66, v66
    v_exp_f32 v67, v67
    v_exp_f32 v68, v68
    v_exp_f32 v69, v69
    v_exp_f32 v70, v70
    v_mfma_f32_32x32x16_bf16 v[216:231], v[116:119], v[12:15], v[32:47]
    v_exp_f32 v71, v71
    v_exp_f32 v72, v72
    v_exp_f32 v73, v73
    v_exp_f32 v74, v74
    v_exp_f32 v75, v75
    v_smfmac_f32_32x32x32_bf16 v[96:111], v[120:123], v[64:71], v136
    s_mov_b64 exec, s[14:15]
    ds_read_b128 v[128:131], v138 offset:9216
    ds_read_b128 v[132:135], v138 offset:9728
    s_mov_b64 exec, -1
    v_exp_f32 v76, v76
    v_exp_f32 v77, v77
    v_exp_f32 v78, v78
    v_exp_f32 v79, v79
    v_exp_f32 v200, v200
    v_exp_f32 v201, v201
    v_smfmac_f32_32x32x32_bf16 v[96:111], v[124:127], v[72:79], v136
    v_exp_f32 v202, v202
    v_exp_f32 v203, v203
    v_exp_f32 v204, v204
    v_exp_f32 v205, v205
    v_exp_f32 v206, v206
    s_waitcnt lgkmcnt(0)
    v_mfma_f32_32x32x16_bf16 v[48:63], v[112:115], v[8:11], v[16:31]
    s_bitcmp1_b32 s59, 2
    s_cbranch_scc1 L_job_red
L_ret_red:
    v_exp_f32 v207, v207
    v_exp_f32 v208, v208
    v_exp_f32 v209, v209
    v_exp_f32 v210, v210
    v_exp_f32 v211, v211
    v_smfmac_f32_32x32x32_bf16 v[80:95], v[128:131], v[200:207], v136
    ds_read_b128 v[116:119], v137 offset:11264
    v_exp_f32 v212, v212
    v_exp_f32 v213, v213
    v_exp_f32 v214, v214
    v_exp_f32 v215, v215
    s_setprio 0
    v_exp_f32 v216, v216
    v_exp_f32 v217, v217
    v_smfmac_f32_32x32x32_bf16 v[80:95], v[132:135], v[208:215], v136
    v_exp_f32 v218, v218
    v_exp_f32 v219, v219
    v_exp_f32 v220, v220
    v_exp_f32 v221, v221
    v_exp_f32 v222, v222
    v_mfma_f32_32x32x16_bf16 v[64:79], v[112:115], v[12:15], v[32:47]
    v_exp_f32 v223, v223
    v_exp_f32 v224, v224
    v_exp_f32 v225, v225
    v_exp_f32 v226, v226
    v_exp_f32 v227, v227
    v_smfmac_f32_32x32x32_bf16 v[96:111], v[128:131], v[216:223], v136
    s_mov_b64 exec, s[14:15]
    ds_read_b128 v[120:123], v138 offset:10240
    ds_read_b128 v[124:127], v138 offset:10752
    s_mov_b64 exec, -1
    v_exp_f32 v228, v228
    v_exp_f32 v229, v229
    v_exp_f32 v230, v230
    v_exp_f32 v231, v231
    v_exp_f32 v48, v48
    v_exp_f32 v49, v49
    v_smfmac_f32_32x32x32_bf16 v[96:111], v[132:135], v[224:231], v136
    s_waitcnt vmcnt(4)
    s_barrier
    v_exp_f32 v50, v50
    v_exp_f32 v51, v51
    v_exp_f32 v52, v52
    v_exp_f32 v53, v53
    v_exp_f32 v54, v54
    s_waitcnt lgkmcnt(0)
    v_mfma_f32_32x32x16_bf16 v[200:215], v[116:119], v[8:11], v[16:31]
    v_exp_f32 v55, v55
    v_exp_f32 v56, v56
    v_exp_f32 v57, v57
    v_exp_f32 v58, v58
    v_exp_f32 v59, v59
    v_smfmac_f32_32x32x32_bf16 v[80:95], v[120:123], v[48:55], v136
    ds_read_b128 v[112:115], v137 offset:12288
    v_exp_f32 v60, v60
    v_exp_f32 v61, v61
    v_exp_f32 v62, v62
    v_exp_f32 v63, v63
    s_setprio 3
    v_exp_f32 v64, v64
    v_exp_f32 v65, v65
    v_smfmac_f32_32x32x32_bf16 v[80:95], v[124:127], v[56:63], v136
    v_exp_f32 v66, v66
    v_exp_f32 v67, v67
    v_exp_f32 v68, v68
    v_exp_f32 v69, v69
    v_exp_f32 v70, v70
    v_mfma_f32_32x32x16_bf16 v[216:231], v[116:119], v[12:15], v[32:47]
    s_bitcmp1_b32 s59, 2
    s_cbranch_scc1 L_job_f5
L_ret_f5:
    v_exp_f32 v71, v71
    v_exp_f32 v72, v72
    v_exp_f32 v73, v73
    v_exp_f32 v74, v74
    v_exp_f32 v75, v75
    v_smfmac_f32_32x32x32_bf16 v[96:111], v[120:123], v[64:71], v136
    s_mov_b64 exec, s[14:15]
    ds_read_b128 v[128:131], v138 offset:11264
    ds_read_b128 v[132:135], v138 offset:11776
    s_mov_b64 exec, -1
    v_exp_f32 v76, v76
    v_exp_f32 v77, v77
    v_exp_f32 v78, v78
    v_exp_f32 v79, v79
    v_exp_f32 v200, v200
    v_exp_f32 v201, v201
    v_smfmac_f32_32x32x32_bf16 v[96:111], v[124:127], v[72:79], v136
    s_add_u32 m0, s54, 4096
    s_add_u32 s4, s65, 32768
    buffer_load_dwordx4 v140, s[16:19], s4 offen lds
    v_exp_f32 v202, v202
    v_exp_f32 v203, v203
    v_exp_f32 v204, v204
    v_exp_f32 v205, v205
    v_exp_f32 v206, v206
    s_waitcnt lgkmcnt(0)
    v_mfma_f32_32x32x16_bf16 v[48:63], v[112:115], v[8:11], v[16:31]
    v_exp_f32 v207, v207
    v_exp_f32 v208, v208
    v_exp_f32 v209, v209
    v_exp_f32 v210, v210
    v_exp_f32 v211, v211
    v_smfmac_f32_32x32x32_bf16 v[80:95], v[128:131], v[200:207], v136
    ds_read_b128 v[116:119], v137 offset:13312
    v_exp_f32 v212, v212
    v_exp_f32 v213, v213
    v_exp_f32 v214, v214
    v_exp_f32 v215, v215
    s_setprio 2
    v_exp_f32 v216, v216
    v_exp_f32 v217, v217
    v_smfmac_f32_32x32x32_bf16 v[80:95], v[132:135], v[208:215], v136
    s_add_u32 m0, s54, 69632
    s_add_u32 s4, s65, 294912
    buffer_load_dwordx4 v140, s[16:19], s4 offen lds
    v_exp_f32 v218, v218
    v_exp_f32 v219, v219
    v_exp_f32 v220, v220
    v_exp_f32 v221, v221
    v_exp_f32 v222, v222
    v_mfma_f32_32x32x16_bf16 v[64:79], v[112:115], v[12:15], v[32:47]
    v_exp_f32 v223, v223
    v_exp_f32 v224, v224
    v_exp_f32 v225, v225
    v_exp_f32 v226, v226
    v_exp_f32 v227, v227
    v_smfmac_f32_32x32x32_bf16 v[96:111], v[128:131], v[216:223], v136
    s_mov_b64 exec, s[14:15]
    ds_read_b128 v[120:123], v138 offset:12288
    ds_read_b128 v[124:127], v138 offset:12800
    s_mov_b64 exec, -1
    v_exp_f32 v228, v228
    v_exp_f32 v229, v229
    v_exp_f32 v230, v230
    v_exp_f32 v231, v231
    v_exp_f32 v48, v48
    v_exp_f32 v49, v49
    v_smfmac_f32_32x32x32_bf16 v[96:111], v[132:135], v[224:231], v136
    s_add_u32 m0, s54, 20480
    s_add_u32 s4, s55, 20480
    buffer_load_dwordx4 v3, s[32:35], s4 offen sc1 lds
    v_exp_f32 v50, v50
    v_exp_f32 v51, v51
    v_exp_f32 v52, v52
    v_exp_f32 v53, v53
    v_exp_f32 v54, v54
    s_waitcnt lgkmcnt(0)
    v_mfma_f32_32x32x16_bf16 v[200:215], v[116:119], v[8:11], v[16:31]
    v_exp_f32 v55, v55
    v_exp_f32 v56, v56
    v_exp_f32 v57, v57
    v_exp_f32 v58, v58
    v_exp_f32 v59, v59
    v_smfmac_f32_32x32x32_bf16 v[80:95], v[120:123], v[48:55], v136
    ds_read_b128 v[112:115], v137 offset:14336
    v_exp_f32 v60, v60
    v_exp_f32 v61, v61
    v_exp_f32 v62, v62
    v_exp_f32 v63, v63
    s_setprio 1
    v_exp_f32 v64, v64
    v_exp_f32 v65, v65
    v_smfmac_f32_32x32x32_bf16 v[80:95], v[124:127], v[56:63], v136
    s_add_u32 m0, s54, 86016
    s_add_u32 s4, s55, 2117632
    buffer_load_dwordx4 v3, s[32:35], s4 offen sc1 lds
    v_exp_f32 v66, v66
    v_exp_f32 v67, v67
    v_exp_f32 v68, v68
    v_exp_f32 v69, v69
    v_exp_f32 v70, v70
    v_mfma_f32_32x32x16_bf16 v[216:231], v[116:119], v[12:15], v[32:47]
    v_exp_f32 v71, v71
    v_exp_f32 v72, v72
    v_exp_f32 v73, v73
    v_exp_f32 v74, v74
    v_exp_f32 v75, v75
    v_smfmac_f32_32x32x32_bf16 v[96:111], v[120:123], v[64:71], v136
    s_mov_b64 exec, s[14:15]
    ds_read_b128 v[128:131], v138 offset:13312
    ds_read_b128 v[132:135], v138 offset:13824
    s_mov_b64 exec, -1
    v_exp_f32 v76, v76
    v_exp_f32 v77, v77
    v_exp_f32 v78, v78
    v_exp_f32 v79, v79
    v_exp_f32 v200, v200
    v_exp_f32 v201, v201
    v_smfmac_f32_32x32x32_bf16 v[96:111], v[124:127], v[72:79], v136
    v_exp_f32 v202, v202
    v_exp_f32 v203, v203
    v_exp_f32 v204, v204
    v_exp_f32 v205, v205
    v_exp_f32 v206, v206
    s_waitcnt lgkmcnt(0)
    v_mfma_f32_32x32x16_bf16 v[48:63], v[112:115], v[8:11], v[16:31]
    v_exp_f32 v207, v207
    v_exp_f32 v208, v208
    v_exp_f32 v209, v209
    v_exp_f32 v210, v210
    v_exp_f32 v211, v211
    v_smfmac_f32_32x32x32_bf16 v[80:95], v[128:131], v[200:207], v136
    ds_read_b128 v[116:119], v137 offset:15360
    v_exp_f32 v212, v212
    v_exp_f32 v213, v213
    v_exp_f32 v214, v214
    v_exp_f32 v215, v215
    s_setprio 0
    v_exp_f32 v216, v216
    v_exp_f32 v217, v217
    v_smfmac_f32_32x32x32_bf16 v[80:95], v[132:135], v[208:215], v136
    v_exp_f32 v218, v218
    v_exp_f32 v219, v219
    v_exp_f32 v220, v220
    v_exp_f32 v221, v221
    v_exp_f32 v222, v222
    v_mfma_f32_32x32x16_bf16 v[64:79], v[112:115], v[12:15], v[32:47]
    v_exp_f32 v223, v223
    v_exp_f32 v224, v224
    v_exp_f32 v225, v225
    v_exp_f32 v226, v226
    v_exp_f32 v227, v227
    v_smfmac_f32_32x32x32_bf16 v[96:111], v[128:131], v[216:223], v136
    s_mov_b64 exec, s[14:15]
    ds_read_b128 v[120:123], v138 offset:14336
    ds_read_b128 v[124:127], v138 offset:14848
    s_mov_b64 exec, -1
    v_exp_f32 v228, v228
    v_exp_f32 v229, v229
    v_exp_f32 v230, v230
    v_exp_f32 v231, v231
    v_exp_f32 v48, v48
    v_exp_f32 v49, v49
    v_smfmac_f32_32x32x32_bf16 v[96:111], v[132:135], v[224:231], v136
    s_waitcnt vmcnt(4)
    s_barrier
    v_exp_f32 v50, v50
    v_exp_f32 v51, v51
    v_exp_f32 v52, v52
    v_exp_f32 v53, v53
    v_exp_f32 v54, v54
    s_waitcnt lgkmcnt(0)
    v_mfma_f32_32x32x16_bf16 v[200:215], v[116:119], v[8:11], v[16:31]
    s_bitcmp1_b32 s59, 3
    s_cbranch_scc0 L_skip_p5
    v_and_b32 v6, 0x7ff, v139
    buffer_load_dword v2, v6, s[32:35], s77 offen sc1
L_skip_p5:
    v_exp_f32 v55, v55
    v_exp_f32 v56, v56
    v_exp_f32 v57, v57
    v_exp_f32 v58, v58
    v_exp_f32 v59, v59
    v_smfmac_f32_32x32x32_bf16 v[80:95], v[120:123], v[48:55], v136
    ds_read_b128 v[112:115], v137 offset:16384
    v_exp_f32 v60, v60
    v_exp_f32 v61, v61
    v_exp_f32 v62, v62
    v_exp_f32 v63, v63
    s_setprio 3
    v_exp_f32 v64, v64
    v_exp_f32 v65, v65
    v_smfmac_f32_32x32x32_bf16 v[80:95], v[124:127], v[56:63], v136
    v_exp_f32 v66, v66
    v_exp_f32 v67, v67
    v_exp_f32 v68, v68
    v_exp_f32 v69, v69
    v_exp_f32 v70, v70
    v_mfma_f32_32x32x16_bf16 v[216:231], v[116:119], v[12:15], v[32:47]
    v_exp_f32 v71, v71
    v_exp_f32 v72, v72
    v_exp_f32 v73, v73
    v_exp_f32 v74, v74
    v_exp_f32 v75, v75
    v_smfmac_f32_32x32x32_bf16 v[96:111], v[120:123], v[64:71], v136
    s_mov_b64 exec, s[14:15]
    ds_read_b128 v[128:131], v138 offset:15360
    ds_read_b128 v[132:135], v138 offset:15872
    s_mov_b64 exec, -1
    v_exp_f32 v76, v76
    v_exp_f32 v77, v77
    v_exp_f32 v78, v78
    v_exp_f32 v79, v79
    v_exp_f32 v200, v200
    v_exp_f32 v201, v201
    v_smfmac_f32_32x32x32_bf16 v[96:111], v[124:127], v[72:79], v136
    s_add_u32 m0, s54, 8192
    s_add_u32 s4, s65, 65536
    buffer_load_dwordx4 v140, s[16:19], s4 offen lds
    v_exp_f32 v202, v202
    v_exp_f32 v203, v203
    v_exp_f32 v204, v204
    v_exp_f32 v205, v205
    v_exp_f32 v206, v206
    s_waitcnt lgkmcnt(0)
    v_mfma_f32_32x32x16_bf16 v[48:63], v[112:115], v[8:11], v[16:31]
    v_exp_f32 v207, v207
    v_exp_f32 v208, v208
    v_exp_f32 v209, v209
    v_exp_f32 v210, v210
    v_exp_f32 v211, v211
    v_smfmac_f32_32x32x32_bf16 v[80:95], v[128:131], v[200:207], v136
    ds_read_b128 v[116:119], v137 offset:17408
    v_exp_f32 v212, v212
    v_exp_f32 v213, v213
    v_exp_f32 v214, v214
    v_exp_f32 v215, v215
    s_setprio 2
    v_exp_f32 v216, v216
    v_exp_f32 v217, v217
    v_smfmac_f32_32x32x32_bf16 v[80:95], v[132:135], v[208:215], v136
    s_add_u32 m0, s54, 73728
    s_add_u32 s4, s65, 327680
    buffer_load_dwordx4 v140, s[16:19], s4 offen lds
    v_exp_f32 v218, v218
    v_exp_f32 v219, v219
    v_exp_f32 v220, v220
    v_exp_f32 v221, v221
    v_exp_f32 v222, v222
    v_mfma_f32_32x32x16_bf16 v[64:79], v[112:115], v[12:15], v[32:47]
    v_exp_f32 v223, v223
    v_exp_f32 v224, v224
    v_exp_f32 v225, v225
    v_exp_f32 v226, v226
    v_exp_f32 v227, v227
    v_smfmac_f32_32x32x32_bf16 v[96:111], v[128:131], v[216:223], v136
    s_mov_b64 exec, s[14:15]
    ds_read_b128 v[120:123], v138 offset:16384
    ds_read_b128 v[124:127], v138 offset:16896
    s_mov_b64 exec, -1
    v_exp_f32 v228, v228
    v_exp_f32 v229, v229
    v_exp_f32 v230, v230
    v_exp_f32 v231, v231
    s_bitcmp1_b32 s59, 3
    s_cbranch_scc1 L_dup32
    v_exp_f32 v48, v48
    v_exp_f32 v49, v49
    v_smfmac_f32_32x32x32_bf16 v[96:111], v[132:135], v[224:231], v136
    s_add_u32 m0, s54, 24576
    s_add_u32 s4, s55, 24576
    buffer_load_dwordx4 v3, s[32:35], s4 offen sc1 lds
    v_exp_f32 v50, v50
    v_exp_f32 v51, v51
    v_exp_f32 v52, v52
    v_exp_f32 v53, v53
    v_exp_f32 v54, v54
    s_waitcnt lgkmcnt(0)
    v_mfma_f32_32x32x16_bf16 v[200:215], v[116:119], v[8:11], v[16:31]
    v_exp_f32 v55, v55
    v_exp_f32 v56, v56
    v_exp_f32 v57, v57
    v_exp_f32 v58, v58
    v_exp_f32 v59, v59
    v_smfmac_f32_32x32x32_bf16 v[80:95], v[120:123], v[48:55], v136
    ds_read_b128 v[112:115], v137 offset:18432
    v_exp_f32 v60, v60
    v_exp_f32 v61, v61
    v_exp_f32 v62, v62
    v_exp_f32 v63, v63
    s_setprio 1
    v_exp_f32 v64, v64
    v_exp_f32 v65, v65
    v_smfmac_f32_32x32x32_bf16 v[80:95], v[124:127], v[56:63], v136
    s_add_u32 m0, s54, 90112
    s_add_u32 s4, s55, 2121728
    buffer_load_dwordx4 v3, s[32:35], s4 offen sc1 lds
    v_exp_f32 v66, v66
    v_exp_f32 v67, v67
    v_exp_f32 v68, v68
    v_exp_f32 v69, v69
    v_exp_f32 v70, v70
    v_mfma_f32_32x32x16_bf16 v[216:231], v[116:119], v[12:15], v[32:47]
    v_exp_f32 v71, v71
    v_exp_f32 v72, v72
    v_exp_f32 v73, v73
    v_exp_f32 v74, v74
    v_exp_f32 v75, v75
    v_smfmac_f32_32x32x32_bf16 v[96:111], v[120:123], v[64:71], v136
    s_mov_b64 exec, s[14:15]
    ds_read_b128 v[128:131], v138 offset:17408
    ds_read_b128 v[132:135], v138 offset:17920
    s_mov_b64 exec, -1
    v_exp_f32 v76, v76
    v_exp_f32 v77, v77
    v_exp_f32 v78, v78
    v_exp_f32 v79, v79
    v_exp_f32 v200, v200
    v_exp_f32 v201, v201
    v_smfmac_f32_32x32x32_bf16 v[96:111], v[124:127], v[72:79], v136
    v_exp_f32 v202, v202
    v_exp_f32 v203, v203
    v_exp_f32 v204, v204
    v_exp_f32 v205, v205
    v_exp_f32 v206, v206
    s_waitcnt lgkmcnt(0)
    v_mfma_f32_32x32x16_bf16 v[48:63], v[112:115], v[8:11], v[16:31]
    v_exp_f32 v207, v207
    v_exp_f32 v208, v208
    v_exp_f32 v209, v209
    v_exp_f32 v210, v210
    v_exp_f32 v211, v211
    v_smfmac_f32_32x32x32_bf16 v[80:95], v[128:131], v[200:207], v136
    ds_read_b128 v[116:119], v137 offset:19456
    v_exp_f32 v212, v212
    v_exp_f32 v213, v213
    v_exp_f32 v214, v214
    v_exp_f32 v215, v215
    s_setprio 0
    v_exp_f32 v216, v216
    v_exp_f32 v217, v217
    v_smfmac_f32_32x32x32_bf16 v[80:95], v[132:135], v[208:215], v136
    v_exp_f32 v218, v218
    v_exp_f32 v219, v219
    v_exp_f32 v220, v220
    v_exp_f32 v221, v221
    v_exp_f32 v222, v222
    v_mfma_f32_32x32x16_bf16 v[64:79], v[112:115], v[12:15], v[32:47]
    v_exp_f32 v223, v223
    v_exp_f32 v224, v224
    v_exp_f32 v225, v225
    v_exp_f32 v226, v226
    v_exp_f32 v227, v227
    v_smfmac_f32_32x32x32_bf16 v[96:111], v[128:131], v[216:223], v136
    s_mov_b64 exec, s[14:15]
    ds_read_b128 v[120:123], v138 offset:18432
    ds_read_b128 v[124:127], v138 offset:18944
    s_mov_b64 exec, -1
    v_exp_f32 v228, v228
    v_exp_f32 v229, v229
    v_exp_f32 v230, v230
    v_exp_f32 v231, v231
    v_exp_f32 v48, v48
    v_exp_f32 v49, v49
    v_smfmac_f32_32x32x32_bf16 v[96:111], v[132:135], v[224:231], v136
    s_waitcnt vmcnt(4)
    s_barrier
    v_exp_f32 v50, v50
    v_exp_f32 v51, v51
    v_exp_f32 v52, v52
    v_exp_f32 v53, v53
    v_exp_f32 v54, v54
    s_waitcnt lgkmcnt(0)
    v_mfma_f32_32x32x16_bf16 v[200:215], v[116:119], v[8:11], v[16:31]
    v_exp_f32 v55, v55
    v_exp_f32 v56, v56
    v_exp_f32 v57, v57
    v_exp_f32 v58, v58
    v_exp_f32 v59, v59
    v_smfmac_f32_32x32x32_bf16 v[80:95], v[120:123], v[48:55], v136
    ds_read_b128 v[112:115], v137 offset:20480
    v_exp_f32 v60, v60
    v_exp_f32 v61, v61
    v_exp_f32 v62, v62
    v_exp_f32 v63, v63
    s_setprio 3
    v_exp_f32 v64, v64
    v_exp_f32 v65, v65
    v_smfmac_f32_32x32x32_bf16 v[80:95], v[124:127], v[56:63], v136
    v_exp_f32 v66, v66
    v_exp_f32 v67, v67
    v_exp_f32 v68, v68
    v_exp_f32 v69, v69
    v_exp_f32 v70, v70
    v_mfma_f32_32x32x16_bf16 v[216:231], v[116:119], v[12:15], v[32:47]
    v_exp_f32 v71, v71
    v_exp_f32 v72, v72
    v_exp_f32 v73, v73
    v_exp_f32 v74, v74
    v_exp_f32 v75, v75
    v_smfmac_f32_32x32x32_bf16 v[96:111], v[120:123], v[64:71], v136
    s_mov_b64 exec, s[14:15]
    ds_read_b128 v[128:131], v138 offset:19456
    ds_read_b128 v[132:135], v138 offset:19968
    s_mov_b64 exec, -1
    v_exp_f32 v76, v76
    v_exp_f32 v77, v77
    v_exp_f32 v78, v78
    v_exp_f32 v79, v79
    v_exp_f32 v200, v200
    v_exp_f32 v201, v201
    v_smfmac_f32_32x32x32_bf16 v[96:111], v[124:127], v[72:79], v136
    s_add_u32 m0, s54, 12288
    s_add_u32 s4, s65, 98304
    buffer_load_dwordx4 v140, s[16:19], s4 offen lds
    v_exp_f32 v202, v202
    v_exp_f32 v203, v203
    v_exp_f32 v204, v204
    v_exp_f32 v205, v205
    v_exp_f32 v206, v206
    s_waitcnt lgkmcnt(0)
    v_mfma_f32_32x32x16_bf16 v[48:63], v[112:115], v[8:11], v[16:31]
    v_exp_f32 v207, v207
    v_exp_f32 v208, v208
    v_exp_f32 v209, v209
    v_exp_f32 v210, v210
    v_exp_f32 v211, v211
    v_smfmac_f32_32x32x32_bf16 v[80:95], v[128:131], v[200:207], v136
    ds_read_b128 v[116:119], v137 offset:21504
    v_exp_f32 v212, v212
    v_exp_f32 v213, v213
    v_exp_f32 v214, v214
    v_exp_f32 v215, v215
    s_setprio 2
    v_exp_f32 v216, v216
    v_exp_f32 v217, v217
    v_smfmac_f32_32x32x32_bf16 v[80:95], v[132:135], v[208:215], v136
    s_add_u32 m0, s54, 77824
    s_add_u32 s4, s65, 360448
    buffer_load_dwordx4 v140, s[16:19], s4 offen lds
    v_exp_f32 v218, v218
    v_exp_f32 v219, v219
    v_exp_f32 v220, v220
    v_exp_f32 v221, v221
    v_exp_f32 v222, v222
    v_mfma_f32_32x32x16_bf16 v[64:79], v[112:115], v[12:15], v[32:47]
    v_exp_f32 v223, v223
    v_exp_f32 v224, v224
    v_exp_f32 v225, v225
    v_exp_f32 v226, v226
    v_exp_f32 v227, v227
    v_smfmac_f32_32x32x32_bf16 v[96:111], v[128:131], v[216:223], v136
    s_mov_b64 exec, s[14:15]
    ds_read_b128 v[120:123], v138 offset:20480
    ds_read_b128 v[124:127], v138 offset:20992
    s_mov_b64 exec, -1
    v_exp_f32 v228, v228
    v_exp_f32 v229, v229
    v_exp_f32 v230, v230
    v_exp_f32 v231, v231
    v_exp_f32 v48, v48
    v_exp_f32 v49, v49
    v_smfmac_f32_32x32x32_bf16 v[96:111], v[132:135], v[224:231], v136
    s_add_u32 m0, s54, 28672
    s_add_u32 s4, s55, 28672
    buffer_load_dwordx4 v3, s[32:35], s4 offen sc1 lds
    v_exp_f32 v50, v50
    v_exp_f32 v51, v51
    v_exp_f32 v52, v52
    v_exp_f32 v53, v53
    v_exp_f32 v54, v54
    s_waitcnt lgkmcnt(0)
    v_mfma_f32_32x32x16_bf16 v[200:215], v[116:119], v[8:11], v[16:31]
    v_exp_f32 v55, v55
    v_exp_f32 v56, v56
    v_exp_f32 v57, v57
    v_exp_f32 v58, v58
    v_exp_f32 v59, v59
    v_smfmac_f32_32x32x32_bf16 v[80:95], v[120:123], v[48:55], v136
    ds_read_b128 v[112:115], v137 offset:22528
    v_exp_f32 v60, v60
    v_exp_f32 v61, v61
    v_exp_f32 v62, v62
    v_exp_f32 v63, v63
    s_setprio 1
    v_exp_f32 v64, v64
    v_exp_f32 v65, v65
    v_smfmac_f32_32x32x32_bf16 v[80:95], v[124:127], v[56:63], v136
    s_add_u32 m0, s54, 94208
    s_add_u32 s4, s55, 2125824
    buffer_load_dwordx4 v3, s[32:35], s4 offen sc1 lds
    v_exp_f32 v66, v66
    v_exp_f32 v67, v67
    v_exp_f32 v68, v68
    v_exp_f32 v69, v69
    v_exp_f32 v70, v70
    v_mfma_f32_32x32x16_bf16 v[216:231], v[116:119], v[12:15], v[32:47]
    v_exp_f32 v71, v71
    v_exp_f32 v72, v72
    v_exp_f32 v73, v73
    v_exp_f32 v74, v74
    v_exp_f32 v75, v75
    v_smfmac_f32_32x32x32_bf16 v[96:111], v[120:123], v[64:71], v136
    s_mov_b64 exec, s[14:15]
    ds_read_b128 v[128:131], v138 offset:21504
    ds_read_b128 v[132:135], v138 offset:22016
    s_mov_b64 exec, -1
    v_exp_f32 v76, v76
    v_exp_f32 v77, v77
    v_exp_f32 v78, v78
    v_exp_f32 v79, v79
L_dupret32:
    v_exp_f32 v200, v200
    v_exp_f32 v201, v201
    v_smfmac_f32_32x32x32_bf16 v[96:111], v[124:127], v[72:79], v136
    v_exp_f32 v202, v202
    v_exp_f32 v203, v203
    v_exp_f32 v204, v204
    v_exp_f32 v205, v205
    v_exp_f32 v206, v206
    s_waitcnt lgkmcnt(0)
    v_mfma_f32_32x32x16_bf16 v[48:63], v[112:115], v[8:11], v[16:31]
    v_exp_f32 v207, v207
    v_exp_f32 v208, v208
    v_exp_f32 v209, v209
    v_exp_f32 v210, v210
    v_exp_f32 v211, v211
    v_smfmac_f32_32x32x32_bf16 v[80:95], v[128:131], v[200:207], v136
    ds_read_b128 v[116:119], v137 offset:23552
    v_exp_f32 v212, v212
    v_exp_f32 v213, v213
    v_exp_f32 v214, v214
    v_exp_f32 v215, v215
    s_setprio 0
    v_exp_f32 v216, v216
    v_exp_f32 v217, v217
    v_smfmac_f32_32x32x32_bf16 v[80:95], v[132:135], v[208:215], v136
    v_exp_f32 v218, v218
    v_exp_f32 v219, v219
    v_exp_f32 v220, v220
    v_exp_f32 v221, v221
    v_exp_f32 v222, v222
    v_mfma_f32_32x32x16_bf16 v[64:79], v[112:115], v[12:15], v[32:47]
    v_exp_f32 v223, v223
    v_exp_f32 v224, v224
    v_exp_f32 v225, v225
    v_exp_f32 v226, v226
    v_exp_f32 v227, v227
    v_smfmac_f32_32x32x32_bf16 v[96:111], v[128:131], v[216:223], v136
    s_mov_b64 exec, s[14:15]
    ds_read_b128 v[120:123], v138 offset:22528
    ds_read_b128 v[124:127], v138 offset:23040
    s_mov_b64 exec, -1
    v_exp_f32 v228, v228
    v_exp_f32 v229, v229
    v_exp_f32 v230, v230
    v_exp_f32 v231, v231
    v_exp_f32 v48, v48
    v_exp_f32 v49, v49
    v_smfmac_f32_32x32x32_bf16 v[96:111], v[132:135], v[224:231], v136
    s_waitcnt vmcnt(0)
    s_barrier
    s_bitcmp1_b32 s59, 4
    s_cbranch_scc1 L_job_f4
L_ret_f4:
    v_exp_f32 v50, v50
    v_exp_f32 v51, v51
    v_exp_f32 v52, v52
    v_exp_f32 v53, v53
    v_exp_f32 v54, v54
    s_waitcnt lgkmcnt(0)
    v_mfma_f32_32x32x16_bf16 v[200:215], v[116:119], v[8:11], v[16:31]
    v_exp_f32 v55, v55
    v_exp_f32 v56, v56
    v_exp_f32 v57, v57
    v_exp_f32 v58, v58
    v_exp_f32 v59, v59
    v_smfmac_f32_32x32x32_bf16 v[80:95], v[120:123], v[48:55], v136
    ds_read_b128 v[112:115], v137 offset:24576
    v_exp_f32 v60, v60
    v_exp_f32 v61, v61
    v_exp_f32 v62, v62
    v_exp_f32 v63, v63
    s_setprio 3
    v_exp_f32 v64, v64
    v_exp_f32 v65, v65
    v_smfmac_f32_32x32x32_bf16 v[80:95], v[124:127], v[56:63], v136
    v_exp_f32 v66, v66
    v_exp_f32 v67, v67
    v_exp_f32 v68, v68
    v_exp_f32 v69, v69
    v_exp_f32 v70, v70
    v_mfma_f32_32x32x16_bf16 v[216:231], v[116:119], v[12:15], v[32:47]
    v_exp_f32 v71, v71
    v_exp_f32 v72, v72
    v_exp_f32 v73, v73
    v_exp_f32 v74, v74
    v_exp_f32 v75, v75
    v_smfmac_f32_32x32x32_bf16 v[96:111], v[120:123], v[64:71], v136
    s_mov_b64 exec, s[14:15]
    ds_read_b128 v[128:131], v138 offset:23552
    ds_read_b128 v[132:135], v138 offset:24064
    s_mov_b64 exec, -1
    v_exp_f32 v76, v76
    v_exp_f32 v77, v77
    v_exp_f32 v78, v78
    v_exp_f32 v79, v79
    v_exp_f32 v200, v200
    v_exp_f32 v201, v201
    v_smfmac_f32_32x32x32_bf16 v[96:111], v[124:127], v[72:79], v136
    s_add_u32 m0, s54, 16384
    s_add_u32 s4, s65, 0
    buffer_load_dwordx4 v140, s[20:23], s4 offen lds
    v_exp_f32 v202, v202
    v_exp_f32 v203, v203
    v_exp_f32 v204, v204
    v_exp_f32 v205, v205
    v_exp_f32 v206, v206
    s_waitcnt lgkmcnt(0)
    v_mfma_f32_32x32x16_bf16 v[48:63], v[112:115], v[8:11], v[16:31]
    v_exp_f32 v207, v207
    v_exp_f32 v208, v208
    v_exp_f32 v209, v209
    v_exp_f32 v210, v210
    v_exp_f32 v211, v211
    v_smfmac_f32_32x32x32_bf16 v[80:95], v[128:131], v[200:207], v136
    ds_read_b128 v[116:119], v137 offset:25600
    v_exp_f32 v212, v212
    v_exp_f32 v213, v213
    v_exp_f32 v214, v214
    v_exp_f32 v215, v215
    s_setprio 2
    v_exp_f32 v216, v216
    v_exp_f32 v217, v217
    v_smfmac_f32_32x32x32_bf16 v[80:95], v[132:135], v[208:215], v136
    s_add_u32 m0, s54, 81920
    s_add_u32 s4, s65, 262144
    buffer_load_dwordx4 v140, s[20:23], s4 offen lds
    v_exp_f32 v218, v218
    v_exp_f32 v219, v219
    v_exp_f32 v220, v220
    v_exp_f32 v221, v221
    v_exp_f32 v222, v222
    v_mfma_f32_32x32x16_bf16 v[64:79], v[112:115], v[12:15], v[32:47]
    v_exp_f32 v223, v223
    v_exp_f32 v224, v224
    v_exp_f32 v225, v225
    v_exp_f32 v226, v226
    v_exp_f32 v227, v227
    v_smfmac_f32_32x32x32_bf16 v[96:111], v[128:131], v[216:223], v136
    s_mov_b64 exec, s[14:15]
    ds_read_b128 v[120:123], v138 offset:24576
    ds_read_b128 v[124:127], v138 offset:25088
    s_mov_b64 exec, -1
    v_exp_f32 v228, v228
    v_exp_f32 v229, v229
    v_exp_f32 v230, v230
    v_exp_f32 v231, v231
    v_exp_f32 v48, v48
    v_exp_f32 v49, v49
    v_smfmac_f32_32x32x32_bf16 v[96:111], v[132:135], v[224:231], v136
    v_exp_f32 v50, v50
    v_exp_f32 v51, v51
    v_exp_f32 v52, v52
    v_exp_f32 v53, v53
    v_exp_f32 v54, v54
    s_waitcnt lgkmcnt(0)
    v_mfma_f32_32x32x16_bf16 v[200:215], v[116:119], v[8:11], v[16:31]
    v_exp_f32 v55, v55
    v_exp_f32 v56, v56
    v_exp_f32 v57, v57
    v_exp_f32 v58, v58
    v_exp_f32 v59, v59
    v_smfmac_f32_32x32x32_bf16 v[80:95], v[120:123], v[48:55], v136
    ds_read_b128 v[112:115], v137 offset:26624
    v_exp_f32 v60, v60
    v_exp_f32 v61, v61
    v_exp_f32 v62, v62
    v_exp_f32 v63, v63
    s_setprio 1
    v_exp_f32 v64, v64
    v_exp_f32 v65, v65
    v_smfmac_f32_32x32x32_bf16 v[80:95], v[124:127], v[56:63], v136
    v_exp_f32 v66, v66
    v_exp_f32 v67, v67
    v_exp_f32 v68, v68
    v_exp_f32 v69, v69
    v_exp_f32 v70, v70
    v_mfma_f32_32x32x16_bf16 v[216:231], v[116:119], v[12:15], v[32:47]
    v_exp_f32 v71, v71
    v_exp_f32 v72, v72
    v_exp_f32 v73, v73
    v_exp_f32 v74, v74
    v_exp_f32 v75, v75
    v_smfmac_f32_32x32x32_bf16 v[96:111], v[120:123], v[64:71], v136
    s_mov_b64 exec, s[14:15]
    ds_read_b128 v[128:131], v138 offset:25600
    ds_read_b128 v[132:135], v138 offset:26112
    s_mov_b64 exec, -1
    v_exp_f32 v76, v76
    v_exp_f32 v77, v77
    v_exp_f32 v78, v78
    v_exp_f32 v79, v79
    v_exp_f32 v200, v200
    v_exp_f32 v201, v201
    v_smfmac_f32_32x32x32_bf16 v[96:111], v[124:127], v[72:79], v136
    v_exp_f32 v202, v202
    v_exp_f32 v203, v203
    v_exp_f32 v204, v204
    v_exp_f32 v205, v205
    v_exp_f32 v206, v206
    s_waitcnt lgkmcnt(0)
    v_mfma_f32_32x32x16_bf16 v[48:63], v[112:115], v[8:11], v[16:31]
    v_exp_f32 v207, v207
    v_exp_f32 v208, v208
    v_exp_f32 v209, v209
    v_exp_f32 v210, v210
    v_exp_f32 v211, v211
    v_smfmac_f32_32x32x32_bf16 v[80:95], v[128:131], v[200:207], v136
    ds_read_b128 v[116:119], v137 offset:27648
    v_exp_f32 v212, v212
    v_exp_f32 v213, v213
    v_exp_f32 v214, v214
    v_exp_f32 v215, v215
    s_setprio 0
    v_exp_f32 v216, v216
    v_exp_f32 v217, v217
    v_smfmac_f32_32x32x32_bf16 v[80:95], v[132:135], v[208:215], v136
    v_exp_f32 v218, v218
    v_exp_f32 v219, v219
    v_exp_f32 v220, v220
    v_exp_f32 v221, v221
    v_exp_f32 v222, v222
    v_mfma_f32_32x32x16_bf16 v[64:79], v[112:115], v[12:15], v[32:47]
    v_exp_f32 v223, v223
    v_exp_f32 v224, v224
    v_exp_f32 v225, v225
    v_exp_f32 v226, v226
    v_exp_f32 v227, v227
    v_smfmac_f32_32x32x32_bf16 v[96:111], v[128:131], v[216:223], v136
    s_mov_b64 exec, s[14:15]
    ds_read_b128 v[120:123], v138 offset:26624
    ds_read_b128 v[124:127], v138 offset:27136
    s_mov_b64 exec, -1
    v_exp_f32 v228, v228
    v_exp_f32 v229, v229
    v_exp_f32 v230, v230
    v_exp_f32 v231, v231
    v_exp_f32 v48, v48
    v_exp_f32 v49, v49
    v_smfmac_f32_32x32x32_bf16 v[96:111], v[132:135], v[224:231], v136
    s_barrier
    v_exp_f32 v50, v50
    v_exp_f32 v51, v51
    v_exp_f32 v52, v52
    v_exp_f32 v53, v53
    v_exp_f32 v54, v54
    s_waitcnt lgkmcnt(0)
    v_mfma_f32_32x32x16_bf16 v[200:215], v[116:119], v[8:11], v[16:31]
    v_and_b32 v6, 0x7ff, v139
    buffer_load_dword v0, v6, s[32:35], s66 offen sc1
    v_exp_f32 v55, v55
    v_exp_f32 v56, v56
    v_exp_f32 v57, v57
    v_exp_f32 v58, v58
    v_exp_f32 v59, v59
    v_smfmac_f32_32x32x32_bf16 v[80:95], v[120:123], v[48:55], v136
    ds_read_b128 v[112:115], v137 offset:28672
    v_exp_f32 v60, v60
    v_exp_f32 v61, v61
    v_exp_f32 v62, v62
    v_exp_f32 v63, v63
    s_setprio 3
    v_exp_f32 v64, v64
    v_exp_f32 v65, v65
    v_smfmac_f32_32x32x32_bf16 v[80:95], v[124:127], v[56:63], v136
    v_exp_f32 v66, v66
    v_exp_f32 v67, v67
    v_exp_f32 v68, v68
    v_exp_f32 v69, v69
    v_exp_f32 v70, v70
    v_mfma_f32_32x32x16_bf16 v[216:231], v[116:119], v[12:15], v[32:47]
    v_exp_f32 v71, v71
    v_exp_f32 v72, v72
    v_exp_f32 v73, v73
    v_exp_f32 v74, v74
    v_exp_f32 v75, v75
    v_smfmac_f32_32x32x32_bf16 v[96:111], v[120:123], v[64:71], v136
    s_mov_b64 exec, s[14:15]
    ds_read_b128 v[128:131], v138 offset:27648
    ds_read_b128 v[132:135], v138 offset:28160
    s_mov_b64 exec, -1
    v_exp_f32 v76, v76
    v_exp_f32 v77, v77
    v_exp_f32 v78, v78
    v_exp_f32 v79, v79
    v_exp_f32 v200, v200
    v_exp_f32 v201, v201
    v_smfmac_f32_32x32x32_bf16 v[96:111], v[124:127], v[72:79], v136
    s_add_u32 m0, s54, 20480
    s_add_u32 s4, s65, 32768
    buffer_load_dwordx4 v140, s[20:23], s4 offen lds
    v_exp_f32 v202, v202
    v_exp_f32 v203, v203
    v_exp_f32 v204, v204
    v_exp_f32 v205, v205
    v_exp_f32 v206, v206
    s_waitcnt lgkmcnt(0)
    v_mfma_f32_32x32x16_bf16 v[48:63], v[112:115], v[8:11], v[16:31]
    v_exp_f32 v207, v207
    v_exp_f32 v208, v208
    v_exp_f32 v209, v209
    v_exp_f32 v210, v210
    v_exp_f32 v211, v211
    v_smfmac_f32_32x32x32_bf16 v[80:95], v[128:131], v[200:207], v136
    ds_read_b128 v[116:119], v137 offset:29696
    v_exp_f32 v212, v212
    v_exp_f32 v213, v213
    v_exp_f32 v214, v214
    v_exp_f32 v215, v215
    s_setprio 2
    v_exp_f32 v216, v216
    v_exp_f32 v217, v217
    v_smfmac_f32_32x32x32_bf16 v[80:95], v[132:135], v[208:215], v136
    s_add_u32 m0, s54, 86016
    s_add_u32 s4, s65, 294912
    buffer_load_dwordx4 v140, s[20:23], s4 offen lds
    v_exp_f32 v218, v218
    v_exp_f32 v219, v219
    v_exp_f32 v220, v220
    v_exp_f32 v221, v221
    v_exp_f32 v222, v222
    v_mfma_f32_32x32x16_bf16 v[64:79], v[112:115], v[12:15], v[32:47]
    v_exp_f32 v223, v223
    v_exp_f32 v224, v224
    v_exp_f32 v225, v225
    v_exp_f32 v226, v226
    v_exp_f32 v227, v227
    v_smfmac_f32_32x32x32_bf16 v[96:111], v[128:131], v[216:223], v136
    s_mov_b64 exec, s[14:15]
    ds_read_b128 v[120:123], v138 offset:28672
    ds_read_b128 v[124:127], v138 offset:29184
    s_mov_b64 exec, -1
    v_exp_f32 v228, v228
    v_exp_f32 v229, v229
    v_exp_f32 v230, v230
    v_exp_f32 v231, v231
    v_exp_f32 v48, v48
    v_exp_f32 v49, v49
    v_smfmac_f32_32x32x32_bf16 v[96:111], v[132:135], v[224:231], v136
    v_exp_f32 v50, v50
    v_exp_f32 v51, v51
    v_exp_f32 v52, v52
    v_exp_f32 v53, v53
    v_exp_f32 v54, v54
    s_waitcnt lgkmcnt(0)
    v_mfma_f32_32x32x16_bf16 v[200:215], v[116:119], v[8:11], v[16:31]
    s_waitcnt vmcnt(2)
    v_cmp_ne_u32 vcc, s36, v0
    s_nop 1
    s_cbranch_vccnz L_pollF4_spin
L_pollF4_back:
    buffer_load_dword v148, v147, s[32:35], s69 offen sc1
    buffer_load_dword v149, v147, s[32:35], s70 offen sc1
    buffer_load_dwordx4 v[152:155], v3, s[32:35], s62 offen offset:0 sc1
    buffer_load_dwordx4 v[156:159], v3, s[32:35], s62 offen offset:1024 sc1
    v_exp_f32 v55, v55
    v_exp_f32 v56, v56
    v_exp_f32 v57, v57
    v_exp_f32 v58, v58
    v_exp_f32 v59, v59
    v_smfmac_f32_32x32x32_bf16 v[80:95], v[120:123], v[48:55], v136
    ds_read_b128 v[112:115], v137 offset:30720
    v_exp_f32 v60, v60
    v_exp_f32 v61, v61
    v_exp_f32 v62, v62
    v_exp_f32 v63, v63
    s_setprio 1
    v_exp_f32 v64, v64
    v_exp_f32 v65, v65
    v_smfmac_f32_32x32x32_bf16 v[80:95], v[124:127], v[56:63], v136
    v_exp_f32 v66, v66
    v_exp_f32 v67, v67
    v_exp_f32 v68, v68
    v_exp_f32 v69, v69
    v_exp_f32 v70, v70
    v_mfma_f32_32x32x16_bf16 v[216:231], v[116:119], v[12:15], v[32:47]
    buffer_load_dwordx4 v[160:163], v3, s[32:35], s62 offen offset:2048 sc1
    buffer_load_dwordx4 v[164:167], v3, s[32:35], s62 offen offset:3072 sc1
    v_exp_f32 v71, v71
    v_exp_f32 v72, v72
    v_exp_f32 v73, v73
    v_exp_f32 v74, v74
    v_exp_f32 v75, v75
    v_smfmac_f32_32x32x32_bf16 v[96:111], v[120:123], v[64:71], v136
    s_mov_b64 exec, s[14:15]
    ds_read_b128 v[128:131], v138 offset:29696
    ds_read_b128 v[132:135], v138 offset:30208
    s_mov_b64 exec, -1
    v_exp_f32 v76, v76
    v_exp_f32 v77, v77
    v_exp_f32 v78, v78
    v_exp_f32 v79, v79
    v_exp_f32 v200, v200
    v_exp_f32 v201, v201
    v_smfmac_f32_32x32x32_bf16 v[96:111], v[124:127], v[72:79], v136
    v_exp_f32 v202, v202
    v_exp_f32 v203, v203
    v_exp_f32 v204, v204
    v_exp_f32 v205, v205
    v_exp_f32 v206, v206
    s_waitcnt lgkmcnt(0)
    v_mfma_f32_32x32x16_bf16 v[48:63], v[112:115], v[8:11], v[16:31]
    buffer_load_dwordx4 v[168:171], v3, s[32:35], s63 offen offset:0 sc1
    buffer_load_dwordx4 v[172:175], v3, s[32:35], s63 offen offset:1024 sc1
    v_exp_f32 v207, v207
    v_exp_f32 v208, v208
    v_exp_f32 v209, v209
    v_exp_f32 v210, v210
    v_exp_f32 v211, v211
    v_smfmac_f32_32x32x32_bf16 v[80:95], v[128:131], v[200:207], v136
    ds_read_b128 v[116:119], v137 offset:31744
    v_exp_f32 v212, v212
    v_exp_f32 v213, v213
    v_exp_f32 v214, v214
    v_exp_f32 v215, v215
    s_setprio 0
    v_exp_f32 v216, v216
    v_exp_f32 v217, v217
    v_smfmac_f32_32x32x32_bf16 v[80:95], v[132:135], v[208:215], v136
    v_exp_f32 v218, v218
    v_exp_f32 v219, v219
    v_exp_f32 v220, v220
    v_exp_f32 v221, v221
    v_exp_f32 v222, v222
    v_mfma_f32_32x32x16_bf16 v[64:79], v[112:115], v[12:15], v[32:47]
    buffer_load_dwordx4 v[176:179], v3, s[32:35], s63 offen offset:2048 sc1
    buffer_load_dwordx4 v[180:183], v3, s[32:35], s63 offen offset:3072 sc1
    v_exp_f32 v223, v223
    v_exp_f32 v224, v224
    v_exp_f32 v225, v225
    v_exp_f32 v226, v226
    v_exp_f32 v227, v227
    v_smfmac_f32_32x32x32_bf16 v[96:111], v[128:131], v[216:223], v136
    s_mov_b64 exec, s[14:15]
    ds_read_b128 v[120:123], v138 offset:30720
    ds_read_b128 v[124:127], v138 offset:31232
    s_mov_b64 exec, -1
    v_exp_f32 v228, v228
    v_exp_f32 v229, v229
    v_exp_f32 v230, v230
    v_exp_f32 v231, v231
    v_exp_f32 v48, v48
    v_exp_f32 v49, v49
    v_smfmac_f32_32x32x32_bf16 v[96:111], v[132:135], v[224:231], v136
    s_barrier
    v_exp_f32 v50, v50
    v_exp_f32 v51, v51
    v_exp_f32 v52, v52
    v_exp_f32 v53, v53
    v_exp_f32 v54, v54
    s_waitcnt lgkmcnt(0)
    v_mfma_f32_32x32x16_bf16 v[200:215], v[116:119], v[8:11], v[16:31]
    v_exp_f32 v55, v55
    v_exp_f32 v56, v56
    v_exp_f32 v57, v57
    v_exp_f32 v58, v58
    v_exp_f32 v59, v59
    v_smfmac_f32_32x32x32_bf16 v[80:95], v[120:123], v[48:55], v136
    v_exp_f32 v60, v60
    v_exp_f32 v61, v61
    v_exp_f32 v62, v62
    v_exp_f32 v63, v63
    s_setprio 3
    v_exp_f32 v64, v64
    v_exp_f32 v65, v65
    v_smfmac_f32_32x32x32_bf16 v[80:95], v[124:127], v[56:63], v136
    v_exp_f32 v66, v66
    v_exp_f32 v67, v67
    v_exp_f32 v68, v68
    v_exp_f32 v69, v69
    v_exp_f32 v70, v70
    v_mfma_f32_32x32x16_bf16 v[216:231], v[116:119], v[12:15], v[32:47]
    v_exp_f32 v71, v71
    v_exp_f32 v72, v72
    v_exp_f32 v73, v73
    v_exp_f32 v74, v74
    v_exp_f32 v75, v75
    v_smfmac_f32_32x32x32_bf16 v[96:111], v[120:123], v[64:71], v136
    s_mov_b64 exec, s[14:15]
    ds_read_b128 v[128:131], v138 offset:31744
    ds_read_b128 v[132:135], v138 offset:32256
    s_mov_b64 exec, -1
    v_exp_f32 v76, v76
    v_exp_f32 v77, v77
    v_exp_f32 v78, v78
    v_exp_f32 v79, v79
    v_exp_f32 v200, v200
    v_exp_f32 v201, v201
    v_smfmac_f32_32x32x32_bf16 v[96:111], v[124:127], v[72:79], v136
    s_add_u32 m0, s54, 24576
    s_add_u32 s4, s65, 65536
    buffer_load_dwordx4 v140, s[20:23], s4 offen lds
    v_exp_f32 v202, v202
    v_exp_f32 v203, v203
    v_exp_f32 v204, v204
    v_exp_f32 v205, v205
    v_exp_f32 v206, v206
    s_waitcnt lgkmcnt(0)
    v_exp_f32 v207, v207
    v_exp_f32 v208, v208
    v_exp_f32 v209, v209
    v_exp_f32 v210, v210
    v_exp_f32 v211, v211
    v_smfmac_f32_32x32x32_bf16 v[80:95], v[128:131], v[200:207], v136
    v_exp_f32 v212, v212
    v_exp_f32 v213, v213
    v_exp_f32 v214, v214
    v_exp_f32 v215, v215
    s_setprio 2
    v_exp_f32 v216, v216
    v_exp_f32 v217, v217
    v_smfmac_f32_32x32x32_bf16 v[80:95], v[132:135], v[208:215], v136
    s_add_u32 m0, s54, 90112
    s_add_u32 s4, s65, 327680
    buffer_load_dwordx4 v140, s[20:23], s4 offen lds
    v_exp_f32 v218, v218
    v_exp_f32 v219, v219
    v_exp_f32 v220, v220
    v_exp_f32 v221, v221
    v_exp_f32 v222, v222
    v_exp_f32 v223, v223
    v_exp_f32 v224, v224
    v_exp_f32 v225, v225
    v_exp_f32 v226, v226
    v_exp_f32 v227, v227
    v_smfmac_f32_32x32x32_bf16 v[96:111], v[128:131], v[216:223], v136
    v_exp_f32 v228, v228
    v_exp_f32 v229, v229
    v_exp_f32 v230, v230
    v_exp_f32 v231, v231
    s_setprio 0
    ds_write_b128 v141, v[80:83]
    ds_write_b128 v141, v[84:87] offset:1024
    v_smfmac_f32_32x32x32_bf16 v[96:111], v[132:135], v[224:231], v136
    ds_write_b32 v141, v88 offset:2048
    v_add_f32_e64 v150, |v80|, |v81|
    v_add_f32_e64 v151, |v82|, |v83|
    v_add_f32_e64 v150, v150, |v84|
    v_add_f32_e64 v151, v151, |v85|
    v_add_f32_e64 v150, v150, |v86|
    v_add_f32_e64 v151, v151, |v87|
    v_add_f32_e64 v150, v150, |v88|
    v_mov_b32 v6, 155648
    v_mov_b32 v7, 1
    v_mov_b32 v5, 0x71800000
    s_nop 0
    v_add_f32_e64 v151, v151, |v96|
    v_add_f32_e64 v150, v150, |v97|
    v_add_f32_e64 v151, v151, |v98|
    v_add_f32_e64 v150, v150, |v99|
    v_add_f32_e64 v151, v151, |v100|
    v_add_f32_e64 v150, v150, |v101|
    v_add_f32_e64 v151, v151, |v102|
    v_add_f32_e64 v150, v150, |v103|
    v_add_f32_e64 v151, v151, |v104|
    v_add_f32 v150, v150, v151
    v_cmp_nlt_f32 vcc, v150, v5
    s_waitcnt vmcnt(10)
    v_sub_f32 v149, 1.0, v149
    s_cbranch_vccz L_noflag
    ds_write_b32 v6, v7
L_noflag:
    s_waitcnt lgkmcnt(0)
    s_barrier
    ds_read_b32 v151, v6
    ds_read_b32 v72, v142 offset:2048
    ds_read_b128 v[64:67], v142
    ds_read_b128 v[68:71], v142 offset:1024
    v_cvt_pk_bf16_f32 v149, v149, v149
    v_lshlrev_b32 v149, 16, v149
    s_waitcnt lgkmcnt(2)
    v_readfirstlane_b32 s5, v151
    v_add_f32 v104, v104, v72
    v_rcp_f32 v150, v104
    s_cmp_lg_u32 s5, 0
    s_cbranch_scc1 L_maybe_fb
L_fin:
    v_mul_f32 v150, v150, v149
    s_waitcnt lgkmcnt(0)
    v_pk_add_f32 v[96:97], v[96:97], v[64:65]
    v_pk_add_f32 v[98:99], v[98:99], v[66:67]
    v_pk_add_f32 v[100:101], v[100:101], v[68:69]
    v_pk_add_f32 v[102:103], v[102:103], v[70:71]
    v_pk_mul_f32 v[96:97], v[96:97], v[150:151] op_sel_hi:[1,0]
    v_pk_mul_f32 v[98:99], v[98:99], v[150:151] op_sel_hi:[1,0]
    v_pk_mul_f32 v[100:101], v[100:101], v[150:151] op_sel_hi:[1,0]
    v_pk_mul_f32 v[102:103], v[102:103], v[150:151] op_sel_hi:[1,0]
    v_cvt_pk_bf16_f32 v20, v96, v97
    v_cvt_pk_bf16_f32 v21, v98, v99
    v_cvt_pk_bf16_f32 v22, v100, v101
    v_cvt_pk_bf16_f32 v23, v102, v103
    v_min_u32 v20, -2, v20
    v_min_u32 v21, -2, v21
    v_min_u32 v22, -2, v22
    v_min_u32 v23, -2, v23
    buffer_store_dwordx4 v[20:23], v3, s[32:35], s61 offen sc1
    s_add_u32 m0, s54, 28672
    s_add_u32 s4, s65, 98304
    buffer_load_dwordx4 v140, s[20:23], s4 offen lds
    s_add_u32 m0, s54, 94208
    s_add_u32 s4, s65, 360448
    buffer_load_dwordx4 v140, s[20:23], s4 offen lds
    ds_read_b64_tr_b16 v[112:113], v143 offset:0
    ds_read_b64_tr_b16 v[114:115], v143 offset:1024
    ds_read_b64_tr_b16 v[116:117], v144 offset:0
    ds_read_b64_tr_b16 v[118:119], v144 offset:1024
    ds_read_b64_tr_b16 v[120:121], v143 offset:2048
    ds_read_b64_tr_b16 v[122:123], v143 offset:3072
    ds_read_b64_tr_b16 v[124:125], v144 offset:2048
    ds_read_b64_tr_b16 v[126:127], v144 offset:3072
    s_add_u32 s62, s62, 32768
    s_add_u32 s63, s63, 32768
    s_mov_b32 s7, 200000
    s_mov_b32 s6, 0
    v_xor_b32 v13, 32768, v145
    v_xor_b32 v14, 65536, v145
    v_xor_b32 v15, 98304, v145
    s_waitcnt vmcnt(3)
    ds_read_b64_tr_b16 v[128:129], v143 offset:4096
    ds_read_b64_tr_b16 v[130:131], v143 offset:5120
    ds_read_b64_tr_b16 v[132:133], v144 offset:4096
    ds_read_b64_tr_b16 v[134:135], v144 offset:5120
    s_waitcnt lgkmcnt(8)
    v_mfma_f32_32x32x16_bf16 v[32:47], v[112:115], v[152:155], 0
    v_mfma_f32_32x32x16_bf16 v[48:63], v[116:119], v[152:155], 0
    ds_read_b64_tr_b16 v[184:185], v143 offset:6144
    ds_read_b64_tr_b16 v[186:187], v143 offset:7168
    ds_read_b64_tr_b16 v[188:189], v144 offset:6144
    ds_read_b64_tr_b16 v[190:191], v144 offset:7168
    s_waitcnt lgkmcnt(8)
    v_mfma_f32_32x32x16_bf16 v[32:47], v[120:123], v[156:159], v[32:47]
    v_mfma_f32_32x32x16_bf16 v[48:63], v[124:127], v[156:159], v[48:63]
    ds_read_b64_tr_b16 v[192:193], v143 offset:8192
    ds_read_b64_tr_b16 v[194:195], v143 offset:9216
    ds_read_b64_tr_b16 v[196:197], v144 offset:8192
    ds_read_b64_tr_b16 v[198:199], v144 offset:9216
    s_waitcnt lgkmcnt(8)
    v_mfma_f32_32x32x16_bf16 v[32:47], v[128:131], v[160:163], v[32:47]
    v_mfma_f32_32x32x16_bf16 v[48:63], v[132:135], v[160:163], v[48:63]
    ds_read_b64_tr_b16 v[200:201], v143 offset:10240
    ds_read_b64_tr_b16 v[202:203], v143 offset:11264
    ds_read_b64_tr_b16 v[204:205], v144 offset:10240
    ds_read_b64_tr_b16 v[206:207], v144 offset:11264
    s_waitcnt lgkmcnt(8)
    v_mfma_f32_32x32x16_bf16 v[32:47], v[184:187], v[164:167], v[32:47]
    v_mfma_f32_32x32x16_bf16 v[48:63], v[188:191], v[164:167], v[48:63]
    ds_read_b64_tr_b16 v[208:209], v143 offset:12288
    ds_read_b64_tr_b16 v[210:211], v143 offset:13312
    ds_read_b64_tr_b16 v[212:213], v144 offset:12288
    ds_read_b64_tr_b16 v[214:215], v144 offset:13312
    s_waitcnt lgkmcnt(8)
    v_mfma_f32_32x32x16_bf16 v[32:47], v[192:195], v[168:171], v[32:47]
    v_mfma_f32_32x32x16_bf16 v[48:63], v[196:199], v[168:171], v[48:63]
    ds_read_b64_tr_b16 v[216:217], v143 offset:14336
    ds_read_b64_tr_b16 v[218:219], v143 offset:15360
    ds_read_b64_tr_b16 v[220:221], v144 offset:14336
    ds_read_b64_tr_b16 v[222:223], v144 offset:15360
    s_waitcnt lgkmcnt(8)
    v_mfma_f32_32x32x16_bf16 v[32:47], v[200:203], v[172:175], v[32:47]
    v_mfma_f32_32x32x16_bf16 v[48:63], v[204:207], v[172:175], v[48:63]
    s_waitcnt lgkmcnt(4)
    v_mfma_f32_32x32x16_bf16 v[32:47], v[208:211], v[176:179], v[32:47]
    v_mfma_f32_32x32x16_bf16 v[48:63], v[212:215], v[176:179], v[48:63]
    s_waitcnt lgkmcnt(0)
    v_mfma_f32_32x32x16_bf16 v[32:47], v[216:219], v[180:183], v[32:47]
    v_mfma_f32_32x32x16_bf16 v[48:63], v[220:223], v[180:183], v[48:63]
    ds_read_b64_tr_b16 v[64:65], v143 offset:16384
    ds_read_b64_tr_b16 v[66:67], v143 offset:17408
    ds_read_b64_tr_b16 v[68:69], v144 offset:16384
    ds_read_b64_tr_b16 v[70:71], v144 offset:17408
    ds_read_b64_tr_b16 v[72:73], v143 offset:18432
    ds_read_b64_tr_b16 v[74:75], v143 offset:19456
    ds_read_b64_tr_b16 v[76:77], v144 offset:18432
    ds_read_b64_tr_b16 v[78:79], v144 offset:19456
    s_waitcnt vmcnt(0)
    s_barrier
    buffer_load_dwordx4 v[224:227], v3, s[32:35], s62 offen offset:0 sc1
    s_waitcnt lgkmcnt(8)
    ds_read_b64_tr_b16 v[80:81], v143 offset:20480
    ds_read_b64_tr_b16 v[82:83], v143 offset:21504
    ds_read_b64_tr_b16 v[84:85], v144 offset:20480
    ds_read_b64_tr_b16 v[86:87], v144 offset:21504
    s_waitcnt lgkmcnt(8)
    ds_read_b64_tr_b16 v[88:89], v143 offset:22528
    ds_read_b64_tr_b16 v[90:91], v143 offset:23552
    ds_read_b64_tr_b16 v[92:93], v144 offset:22528
    ds_read_b64_tr_b16 v[94:95], v144 offset:23552
    v_pk_mul_f32 v[32:33], v[32:33], v[148:149] op_sel_hi:[1,0]
    v_pk_mul_f32 v[34:35], v[34:35], v[148:149] op_sel_hi:[1,0]
    v_pk_mul_f32 v[36:37], v[36:37], v[148:149] op_sel_hi:[1,0]
    v_pk_mul_f32 v[38:39], v[38:39], v[148:149] op_sel_hi:[1,0]
    buffer_load_dwordx4 v[228:231], v3, s[32:35], s62 offen offset:1024 sc1
    s_waitcnt lgkmcnt(8)
    ds_read_b64_tr_b16 v[96:97], v143 offset:24576
    ds_read_b64_tr_b16 v[98:99], v143 offset:25600
    ds_read_b64_tr_b16 v[100:101], v144 offset:24576
    ds_read_b64_tr_b16 v[102:103], v144 offset:25600
    s_waitcnt lgkmcnt(8)
    ds_read_b64_tr_b16 v[104:105], v143 offset:26624
    ds_read_b64_tr_b16 v[106:107], v143 offset:27648
    ds_read_b64_tr_b16 v[108:109], v144 offset:26624
    ds_read_b64_tr_b16 v[110:111], v144 offset:27648
    v_pk_mul_f32 v[40:41], v[40:41], v[148:149] op_sel_hi:[1,0]
    v_pk_mul_f32 v[42:43], v[42:43], v[148:149] op_sel_hi:[1,0]
    v_pk_mul_f32 v[44:45], v[44:45], v[148:149] op_sel_hi:[1,0]
    v_pk_mul_f32 v[46:47], v[46:47], v[148:149] op_sel_hi:[1,0]
    buffer_load_dwordx4 v[232:235], v3, s[32:35], s62 offen offset:2048 sc1
    s_waitcnt lgkmcnt(8)
    ds_read_b64_tr_b16 v[112:113], v143 offset:28672
    ds_read_b64_tr_b16 v[114:115], v143 offset:29696
    ds_read_b64_tr_b16 v[116:117], v144 offset:28672
    ds_read_b64_tr_b16 v[118:119], v144 offset:29696
    s_waitcnt lgkmcnt(8)
    ds_read_b64_tr_b16 v[120:121], v143 offset:30720
    ds_read_b64_tr_b16 v[122:123], v143 offset:31744
    ds_read_b64_tr_b16 v[124:125], v144 offset:30720
    ds_read_b64_tr_b16 v[126:127], v144 offset:31744
    v_pk_mul_f32 v[48:49], v[48:49], v[148:149] op_sel_hi:[1,0]
    v_pk_mul_f32 v[50:51], v[50:51], v[148:149] op_sel_hi:[1,0]
    v_pk_mul_f32 v[52:53], v[52:53], v[148:149] op_sel_hi:[1,0]
    v_pk_mul_f32 v[54:55], v[54:55], v[148:149] op_sel_hi:[1,0]
    buffer_load_dwordx4 v[236:239], v3, s[32:35], s62 offen offset:3072 sc1
    v_pk_mul_f32 v[56:57], v[56:57], v[148:149] op_sel_hi:[1,0]
    v_pk_mul_f32 v[58:59], v[58:59], v[148:149] op_sel_hi:[1,0]
    v_pk_mul_f32 v[60:61], v[60:61], v[148:149] op_sel_hi:[1,0]
    v_pk_mul_f32 v[62:63], v[62:63], v[148:149] op_sel_hi:[1,0]
    buffer_load_dwordx4 v[240:243], v3, s[32:35], s63 offen offset:0 sc1
    s_waitcnt vmcnt(4) lgkmcnt(0)
L_ot0:
    v_max3_u32 v4, v224, v225, v226
    v_max_u32 v4, v4, v227
    v_cmp_eq_u32 vcc, -1, v4
    s_nop 1
    s_cbranch_vccnz L_obad0
L_og0:
    v_mfma_f32_32x32x16_bf16 v[32:47], v[64:67], v[224:227], v[32:47]
    v_mfma_f32_32x32x16_bf16 v[48:63], v[68:71], v[224:227], v[48:63]
    buffer_load_dwordx4 v[244:247], v3, s[32:35], s63 offen offset:1024 sc1
    s_waitcnt vmcnt(4)
L_ot1:
    v_max3_u32 v4, v228, v229, v230
    v_max_u32 v4, v4, v231
    v_cmp_eq_u32 vcc, -1, v4
    s_nop 1
    s_cbranch_vccnz L_obad1
L_og1:
    v_mfma_f32_32x32x16_bf16 v[32:47], v[72:75], v[228:231], v[32:47]
    v_mfma_f32_32x32x16_bf16 v[48:63], v[76:79], v[228:231], v[48:63]
    buffer_load_dwordx4 v[248:251], v3, s[32:35], s63 offen offset:2048 sc1
    s_waitcnt vmcnt(4)
L_ot2:
    v_max3_u32 v4, v232, v233, v234
    v_max_u32 v4, v4, v235
    v_cmp_eq_u32 vcc, -1, v4
    s_nop 1
    s_cbranch_vccnz L_obad2
L_og2:
    v_mfma_f32_32x32x16_bf16 v[32:47], v[80:83], v[232:235], v[32:47]
    v_mfma_f32_32x32x16_bf16 v[48:63], v[84:87], v[232:235], v[48:63]
    buffer_load_dwordx4 v[252:255], v3, s[32:35], s63 offen offset:3072 sc1
    s_waitcnt vmcnt(4)
L_ot3:
    v_max3_u32 v4, v236, v237, v238
    v_max_u32 v4, v4, v239
    v_cmp_eq_u32 vcc, -1, v4
    s_nop 1
    s_cbranch_vccnz L_obad3
L_og3:
    v_mfma_f32_32x32x16_bf16 v[32:47], v[88:91], v[236:239], v[32:47]
    v_mfma_f32_32x32x16_bf16 v[48:63], v[92:95], v[236:239], v[48:63]
    s_waitcnt vmcnt(3)
L_ot4:
    v_max3_u32 v4, v240, v241, v242
    v_max_u32 v4, v4, v243
    v_cmp_eq_u32 vcc, -1, v4
    s_nop 1
    s_cbranch_vccnz L_obad4
L_og4:
    v_mfma_f32_32x32x16_bf16 v[32:47], v[96:99], v[240:243], v[32:47]
    v_mfma_f32_32x32x16_bf16 v[48:63], v[100:103], v[240:243], v[48:63]
    s_waitcnt vmcnt(2)
L_ot5:
    v_max3_u32 v4, v244, v245, v246
    v_max_u32 v4, v4, v247
    v_cmp_eq_u32 vcc, -1, v4
    s_nop 1
    s_cbranch_vccnz L_obad5
L_og5:
    v_mfma_f32_32x32x16_bf16 v[32:47], v[104:107], v[244:247], v[32:47]
    v_mfma_f32_32x32x16_bf16 v[48:63], v[108:111], v[244:247], v[48:63]
    s_waitcnt vmcnt(1)
L_ot6:
    v_max3_u32 v4, v248, v249, v250
    v_max_u32 v4, v4, v251
    v_cmp_eq_u32 vcc, -1, v4
    s_nop 1
    s_cbranch_vccnz L_obad6
L_og6:
    v_mfma_f32_32x32x16_bf16 v[32:47], v[112:115], v[248:251], v[32:47]
    v_mfma_f32_32x32x16_bf16 v[48:63], v[116:119], v[248:251], v[48:63]
    s_waitcnt vmcnt(0)
L_ot7:
    v_max3_u32 v4, v252, v253, v254
    v_max_u32 v4, v4, v255
    v_cmp_eq_u32 vcc, -1, v4
    s_nop 1
    s_cbranch_vccnz L_obad7
L_og7:
    v_mfma_f32_32x32x16_bf16 v[32:47], v[120:123], v[252:255], v[32:47]
    v_mfma_f32_32x32x16_bf16 v[48:63], v[124:127], v[252:255], v[48:63]
    s_nop 10
    ds_write_b128 v13, v[40:43] offset:0
    ds_write_b128 v13, v[44:47] offset:1024
    ds_write_b128 v14, v[48:51] offset:2048
    ds_write_b128 v14, v[52:55] offset:3072
    ds_write_b128 v15, v[56:59] offset:4096
    ds_write_b128 v15, v[60:63] offset:5120
    s_waitcnt lgkmcnt(0)
    s_barrier
    ds_read_b128 v[64:67], v145 offset:0
    ds_read_b128 v[68:71], v145 offset:1024
    ds_read_b128 v[72:75], v145 offset:2048
    ds_read_b128 v[76:79], v145 offset:3072
    ds_read_b128 v[80:83], v145 offset:4096
    ds_read_b128 v[84:87], v145 offset:5120
    s_waitcnt lgkmcnt(4)
    v_pk_add_f32 v[64:65], v[64:65], v[32:33]
    v_pk_add_f32 v[66:67], v[66:67], v[34:35]
    v_pk_add_f32 v[68:69], v[68:69], v[36:37]
    v_pk_add_f32 v[70:71], v[70:71], v[38:39]
    s_waitcnt lgkmcnt(0)
    v_pk_add_f32 v[72:73], v[72:73], v[80:81]
    v_pk_add_f32 v[74:75], v[74:75], v[82:83]
    v_pk_add_f32 v[76:77], v[76:77], v[84:85]
    v_pk_add_f32 v[78:79], v[78:79], v[86:87]
    v_pk_add_f32 v[64:65], v[64:65], v[72:73]
    v_pk_add_f32 v[66:67], v[66:67], v[74:75]
    v_pk_add_f32 v[68:69], v[68:69], v[76:77]
    v_pk_add_f32 v[70:71], v[70:71], v[78:79]
    v_cvt_pk_bf16_f32 v20, v64, v65
    v_cvt_pk_bf16_f32 v21, v66, v67
    v_cvt_pk_bf16_f32 v22, v68, v69
    v_cvt_pk_bf16_f32 v23, v70, v71
    s_nop 0
    v_permlane32_swap_b32 v20, v22
    v_permlane32_swap_b32 v21, v23
    buffer_store_dwordx4 v[20:23], v146, s[24:27], s64 offen
    s_or_b32 s4, s2, s3
    s_cmp_lg_u32 s4, 0
    s_cbranch_scc1 L_noE
    v_mov_b32 v24, s36
    s_mov_b64 exec, 1
    buffer_store_dword v24, v3, s[32:35], 0 offen offset:0
    s_mov_b64 exec, -1
L_noE:
L_end:
    s_endpgm
L_job_f2:
    v_mov_b32 v4, s36
    s_mov_b64 exec, 1
    buffer_store_dword v4, v3, s[32:35], s50 offen sc1
    s_mov_b64 exec, -1
    s_branch L_ret_f2
L_job_p2:
    v_and_b32 v6, 0x7ff, v139
    buffer_load_dword v0, v6, s[32:35], s51 offen sc1
    s_branch L_ret_p2
L_job_ld:
    s_waitcnt vmcnt(1)
    v_cmp_ne_u32 vcc, s36, v0
    s_nop 1
    s_cbranch_vccnz L_pollF2_spin
L_pollF2_back:
    v_lshrrev_b32 v5, 4, v1
    v_lshlrev_b32 v5, 14, v5
    v_and_b32 v6, 0xf0, v3
    v_add_u32 v6, v6, v5
    s_lshr_b32 s5, s2, 5
    s_mul_i32 s5, s5, 240
    s_sub_u32 s5, s74, s5
    s_add_u32 s6, s74, 0
    buffer_load_dwordx4 v[152:155], v6, s[32:35], s6 offen sc1
    s_add_u32 s6, s74, 4096
    buffer_load_dwordx4 v[156:159], v6, s[32:35], s6 offen sc1
    s_add_u32 s6, s74, 8192
    buffer_load_dwordx4 v[160:163], v6, s[32:35], s6 offen sc1
    s_add_u32 s6, s74, 12288
    buffer_load_dwordx4 v[164:167], v6, s[32:35], s6 offen sc1
    s_add_u32 s6, s5, 0
    buffer_load_dwordx4 v[168:171], v5, s[32:35], s6 offen offset:2048 sc1
    s_add_u32 s6, s5, 4096
    buffer_load_dwordx4 v[172:175], v5, s[32:35], s6 offen offset:2048 sc1
    s_add_u32 s6, s5, 8192
    buffer_load_dwordx4 v[176:179], v5, s[32:35], s6 offen offset:2048 sc1
    s_add_u32 s6, s5, 12288
    buffer_load_dwordx4 v[180:183], v5, s[32:35], s6 offen offset:2048 sc1
    s_branch L_ret_ld
L_job_red:
    s_waitcnt vmcnt(3)
    v_pk_add_f32 v[152:153], v[152:153], v[156:157]
    v_pk_add_f32 v[160:161], v[160:161], v[164:165]
    v_pk_add_f32 v[154:155], v[154:155], v[158:159]
    v_pk_add_f32 v[162:163], v[162:163], v[166:167]
    v_pk_add_f32 v[168:169], v[168:169], v[172:173]
    v_pk_add_f32 v[176:177], v[176:177], v[180:181]
    v_pk_add_f32 v[170:171], v[170:171], v[174:175]
    v_pk_add_f32 v[178:179], v[178:179], v[182:183]
    v_pk_add_f32 v[152:153], v[152:153], v[160:161]
    v_pk_add_f32 v[154:155], v[154:155], v[162:163]
    v_pk_add_f32 v[168:169], v[168:169], v[176:177]
    v_pk_add_f32 v[170:171], v[170:171], v[178:179]
    v_mov_b64 v[156:157], v[152:153]
    v_mov_b64 v[158:159], v[154:155]
    v_mov_b64 v[172:173], v[168:169]
    v_mov_b64 v[174:175], v[170:171]
    v_permlane32_swap_b32 v152, v156
    v_permlane32_swap_b32 v153, v157
    v_permlane32_swap_b32 v154, v158
    v_permlane32_swap_b32 v155, v159
    v_permlane32_swap_b32 v168, v172
    v_permlane32_swap_b32 v169, v173
    v_permlane32_swap_b32 v170, v174
    v_permlane32_swap_b32 v171, v175
    v_pk_add_f32 v[152:153], v[152:153], v[156:157]
    v_pk_add_f32 v[154:155], v[154:155], v[158:159]
    v_pk_add_f32 v[168:169], v[168:169], v[172:173]
    v_pk_add_f32 v[170:171], v[170:171], v[174:175]
    v_mov_b64 v[156:157], v[152:153]
    v_mov_b64 v[158:159], v[154:155]
    v_mov_b64 v[172:173], v[168:169]
    v_mov_b64 v[174:175], v[170:171]
    v_permlane16_swap_b32 v152, v156
    v_permlane16_swap_b32 v153, v157
    v_permlane16_swap_b32 v154, v158
    v_permlane16_swap_b32 v155, v159
    v_permlane16_swap_b32 v168, v172
    v_permlane16_swap_b32 v169, v173
    v_permlane16_swap_b32 v170, v174
    v_permlane16_swap_b32 v171, v175
    v_pk_add_f32 v[152:153], v[152:153], v[156:157]
    v_pk_add_f32 v[154:155], v[154:155], v[158:159]
    v_pk_add_f32 v[168:169], v[168:169], v[172:173]
    v_pk_add_f32 v[170:171], v[170:171], v[174:175]
    v_cmp_eq_u32 vcc, 16, v1
    v_cvt_pk_bf16_f32 v156, v152, v153
    v_cvt_pk_bf16_f32 v157, v154, v155
    v_cvt_pk_bf16_f32 v172, v168, v169
    v_cvt_pk_bf16_f32 v173, v170, v171
    v_cndmask_b32 v156, v156, v172, vcc
    v_cndmask_b32 v157, v157, v173, vcc
    s_mov_b64 exec, 0x1ffff
    buffer_store_dwordx2 v[156:157], v3, s[32:35], s75 offen sc1
    s_mov_b64 exec, -1
    s_branch L_ret_red
L_job_f5:
    s_waitcnt vmcnt(0)
    v_mov_b32 v4, s36
    s_mov_b64 exec, 1
    buffer_store_dword v4, v3, s[32:35], s76 offen sc1
    s_mov_b64 exec, -1
    s_branch L_ret_f5
L_dup32:
    v_exp_f32 v48, v48
    v_exp_f32 v49, v49
    v_smfmac_f32_32x32x32_bf16 v[96:111], v[132:135], v[224:231], v136
    s_add_u32 m0, s54, 24576
    s_add_u32 s4, s55, 24576
    buffer_load_dwordx4 v3, s[32:35], s4 offen sc1 lds
    v_exp_f32 v50, v50
    v_exp_f32 v51, v51
    v_exp_f32 v52, v52
    v_exp_f32 v53, v53
    v_exp_f32 v54, v54
    s_waitcnt lgkmcnt(0)
    v_mfma_f32_32x32x16_bf16 v[200:215], v[116:119], v[8:11], v[16:31]
    s_waitcnt vmcnt(3)
    v_cmp_ne_u32 vcc, s36, v2
    s_nop 1
    s_cbranch_vccnz L_pollF5_spin
L_pollF5_back:
    v_exp_f32 v55, v55
    v_min_u32 v5, 64, v147
    v_exp_f32 v56, v56
    v_lshrrev_b32 v6, 5, v1
    v_exp_f32 v57, v57
    v_mul_u32_u24 v6, 272, v6
    v_exp_f32 v58, v58
    v_lshl_add_u32 v5, v5, 2, v6
    v_exp_f32 v59, v59
    v_smfmac_f32_32x32x32_bf16 v[80:95], v[120:123], v[48:55], v136
    ds_read_b128 v[112:115], v137 offset:18432
    v_exp_f32 v60, v60
    v_exp_f32 v61, v61
    buffer_load_dwordx4 v[152:155], v5, s[32:35], s78 offen offset:0 sc1
    v_exp_f32 v62, v62
    v_exp_f32 v63, v63
    s_setprio 1
    v_exp_f32 v64, v64
    v_exp_f32 v65, v65
    v_smfmac_f32_32x32x32_bf16 v[80:95], v[124:127], v[56:63], v136
    s_add_u32 m0, s54, 90112
    s_add_u32 s4, s55, 2121728
    buffer_load_dwordx4 v3, s[32:35], s4 offen sc1 lds
    v_exp_f32 v66, v66
    v_exp_f32 v67, v67
    buffer_load_dwordx4 v[156:159], v5, s[32:35], s78 offen offset:544 sc1
    v_exp_f32 v68, v68
    v_exp_f32 v69, v69
    v_exp_f32 v70, v70
    v_mfma_f32_32x32x16_bf16 v[216:231], v[116:119], v[12:15], v[32:47]
    v_exp_f32 v71, v71
    v_exp_f32 v72, v72
    buffer_load_dwordx4 v[160:163], v5, s[32:35], s78 offen offset:2048 sc1
    v_exp_f32 v73, v73
    v_exp_f32 v74, v74
    v_exp_f32 v75, v75
    v_smfmac_f32_32x32x32_bf16 v[96:111], v[120:123], v[64:71], v136
    s_mov_b64 exec, s[14:15]
    ds_read_b128 v[128:131], v138 offset:17408
    ds_read_b128 v[132:135], v138 offset:17920
    s_mov_b64 exec, -1
    v_exp_f32 v76, v76
    v_exp_f32 v77, v77
    buffer_load_dwordx4 v[164:167], v5, s[32:35], s78 offen offset:2592 sc1
    v_exp_f32 v78, v78
    v_exp_f32 v79, v79
    v_exp_f32 v200, v200
    v_exp_f32 v201, v201
    v_smfmac_f32_32x32x32_bf16 v[96:111], v[124:127], v[72:79], v136
    v_exp_f32 v202, v202
    v_exp_f32 v203, v203
    v_exp_f32 v204, v204
    v_exp_f32 v205, v205
    v_exp_f32 v206, v206
    s_waitcnt lgkmcnt(0)
    v_mfma_f32_32x32x16_bf16 v[48:63], v[112:115], v[8:11], v[16:31]
    v_exp_f32 v207, v207
    v_exp_f32 v208, v208
    v_exp_f32 v209, v209
    v_exp_f32 v210, v210
    v_exp_f32 v211, v211
    v_smfmac_f32_32x32x32_bf16 v[80:95], v[128:131], v[200:207], v136
    ds_read_b128 v[116:119], v137 offset:19456
    v_exp_f32 v212, v212
    v_exp_f32 v213, v213
    v_exp_f32 v214, v214
    v_exp_f32 v215, v215
    s_setprio 0
    v_exp_f32 v216, v216
    v_exp_f32 v217, v217
    v_smfmac_f32_32x32x32_bf16 v[80:95], v[132:135], v[208:215], v136
    v_exp_f32 v218, v218
    v_exp_f32 v219, v219
    v_exp_f32 v220, v220
    v_exp_f32 v221, v221
    v_exp_f32 v222, v222
    v_mfma_f32_32x32x16_bf16 v[64:79], v[112:115], v[12:15], v[32:47]
    v_exp_f32 v223, v223
    v_exp_f32 v224, v224
    v_exp_f32 v225, v225
    v_exp_f32 v226, v226
    v_exp_f32 v227, v227
    v_smfmac_f32_32x32x32_bf16 v[96:111], v[128:131], v[216:223], v136
    s_mov_b64 exec, s[14:15]
    ds_read_b128 v[120:123], v138 offset:18432
    ds_read_b128 v[124:127], v138 offset:18944
    s_mov_b64 exec, -1
    v_exp_f32 v228, v228
    v_exp_f32 v229, v229
    v_exp_f32 v230, v230
    v_exp_f32 v231, v231
    v_exp_f32 v48, v48
    v_exp_f32 v49, v49
    v_smfmac_f32_32x32x32_bf16 v[96:111], v[132:135], v[224:231], v136
    s_waitcnt vmcnt(4)
    s_barrier
    v_exp_f32 v50, v50
    v_exp_f32 v51, v51
    v_exp_f32 v52, v52
    v_exp_f32 v53, v53
    v_exp_f32 v54, v54
    s_waitcnt lgkmcnt(0)
    v_mfma_f32_32x32x16_bf16 v[200:215], v[116:119], v[8:11], v[16:31]
    s_waitcnt vmcnt(0)
    v_mfma_f32_32x32x16_bf16 v[168:183], v[152:155], v[232:235], 0
    v_exp_f32 v55, v55
    v_exp_f32 v56, v56
    v_mfma_f32_32x32x16_bf16 v[184:199], v[160:163], v[240:243], 0
    v_exp_f32 v57, v57
    v_exp_f32 v58, v58
    v_exp_f32 v59, v59
    v_smfmac_f32_32x32x32_bf16 v[80:95], v[120:123], v[48:55], v136
    ds_read_b128 v[112:115], v137 offset:20480
    v_exp_f32 v60, v60
    v_exp_f32 v61, v61
    v_mfma_f32_32x32x16_bf16 v[168:183], v[156:159], v[236:239], v[168:183]
    v_exp_f32 v62, v62
    v_exp_f32 v63, v63
    s_setprio 3
    v_exp_f32 v64, v64
    v_exp_f32 v65, v65
    v_smfmac_f32_32x32x32_bf16 v[80:95], v[124:127], v[56:63], v136
    v_exp_f32 v66, v66
    v_exp_f32 v67, v67
    v_mfma_f32_32x32x16_bf16 v[184:199], v[164:167], v[244:247], v[184:199]
    v_exp_f32 v68, v68
    v_exp_f32 v69, v69
    v_exp_f32 v70, v70
    v_mfma_f32_32x32x16_bf16 v[216:231], v[116:119], v[12:15], v[32:47]
    v_exp_f32 v71, v71
    v_exp_f32 v72, v72
    v_exp_f32 v73, v73
    v_exp_f32 v74, v74
    v_exp_f32 v75, v75
    v_smfmac_f32_32x32x32_bf16 v[96:111], v[120:123], v[64:71], v136
    s_mov_b64 exec, s[14:15]
    ds_read_b128 v[128:131], v138 offset:19456
    ds_read_b128 v[132:135], v138 offset:19968
    s_mov_b64 exec, -1
    v_exp_f32 v76, v76
    v_exp_f32 v77, v77
    v_exp_f32 v78, v78
    v_exp_f32 v79, v79
    v_exp_f32 v200, v200
    v_exp_f32 v201, v201
    v_smfmac_f32_32x32x32_bf16 v[96:111], v[124:127], v[72:79], v136
    s_add_u32 m0, s54, 12288
    s_add_u32 s4, s65, 98304
    buffer_load_dwordx4 v140, s[16:19], s4 offen lds
    v_exp_f32 v202, v202
    v_exp_f32 v203, v203
    v_exp_f32 v204, v204
    v_exp_f32 v205, v205
    v_exp_f32 v206, v206
    s_waitcnt lgkmcnt(0)
    v_mfma_f32_32x32x16_bf16 v[48:63], v[112:115], v[8:11], v[16:31]
    v_exp_f32 v207, v207
    v_exp_f32 v208, v208
    v_exp_f32 v209, v209
    v_exp_f32 v210, v210
    v_exp_f32 v211, v211
    v_smfmac_f32_32x32x32_bf16 v[80:95], v[128:131], v[200:207], v136
    ds_read_b128 v[116:119], v137 offset:21504
    v_exp_f32 v212, v212
    v_exp_f32 v213, v213
    v_exp_f32 v214, v214
    v_exp_f32 v215, v215
    s_setprio 2
    v_exp_f32 v216, v216
    v_exp_f32 v217, v217
    v_smfmac_f32_32x32x32_bf16 v[80:95], v[132:135], v[208:215], v136
    s_add_u32 m0, s54, 77824
    s_add_u32 s4, s65, 360448
    buffer_load_dwordx4 v140, s[16:19], s4 offen lds
    v_exp_f32 v218, v218
    v_exp_f32 v219, v219
    v_exp_f32 v220, v220
    v_exp_f32 v221, v221
    v_exp_f32 v222, v222
    v_mfma_f32_32x32x16_bf16 v[64:79], v[112:115], v[12:15], v[32:47]
    v_add_f32 v4, 0x358637bd, v176
    v_exp_f32 v223, v223
    v_rcp_f32 v4, v4
    v_exp_f32 v224, v224
    v_pk_mul_f32 v[168:169], v[168:169], v[4:5] op_sel_hi:[1,0]
    v_exp_f32 v225, v225
    v_pk_mul_f32 v[170:171], v[170:171], v[4:5] op_sel_hi:[1,0]
    v_exp_f32 v226, v226
    v_pk_mul_f32 v[172:173], v[172:173], v[4:5] op_sel_hi:[1,0]
    v_exp_f32 v227, v227
    v_smfmac_f32_32x32x32_bf16 v[96:111], v[128:131], v[216:223], v136
    s_mov_b64 exec, s[14:15]
    ds_read_b128 v[120:123], v138 offset:20480
    ds_read_b128 v[124:127], v138 offset:20992
    s_mov_b64 exec, -1
    v_exp_f32 v228, v228
    v_pk_mul_f32 v[174:175], v[174:175], v[4:5] op_sel_hi:[1,0]
    v_exp_f32 v229, v229
    v_cvt_pk_bf16_f32 v152, v168, v169
    v_exp_f32 v230, v230
    v_cvt_pk_bf16_f32 v153, v170, v171
    v_exp_f32 v231, v231
    v_cvt_pk_bf16_f32 v154, v172, v173
    v_exp_f32 v48, v48
    v_cvt_pk_bf16_f32 v155, v174, v175
    v_exp_f32 v49, v49
    v_smfmac_f32_32x32x32_bf16 v[96:111], v[132:135], v[224:231], v136
    s_add_u32 m0, s54, 28672
    s_add_u32 s4, s55, 28672
    buffer_load_dwordx4 v3, s[32:35], s4 offen sc1 lds
    v_exp_f32 v50, v50
    v_exp_f32 v51, v51
    buffer_store_dwordx4 v[152:155], v3, s[32:35], s79 offen offset:0 sc1
    v_exp_f32 v52, v52
    v_exp_f32 v53, v53
    v_exp_f32 v54, v54
    s_waitcnt lgkmcnt(0)
    v_mfma_f32_32x32x16_bf16 v[200:215], v[116:119], v[8:11], v[16:31]
    v_add_f32 v4, 0x358637bd, v192
    v_exp_f32 v55, v55
    v_rcp_f32 v4, v4
    v_exp_f32 v56, v56
    v_pk_mul_f32 v[184:185], v[184:185], v[4:5] op_sel_hi:[1,0]
    v_exp_f32 v57, v57
    v_pk_mul_f32 v[186:187], v[186:187], v[4:5] op_sel_hi:[1,0]
    v_exp_f32 v58, v58
    v_pk_mul_f32 v[188:189], v[188:189], v[4:5] op_sel_hi:[1,0]
    v_exp_f32 v59, v59
    v_smfmac_f32_32x32x32_bf16 v[80:95], v[120:123], v[48:55], v136
    ds_read_b128 v[112:115], v137 offset:22528
    v_exp_f32 v60, v60
    v_pk_mul_f32 v[190:191], v[190:191], v[4:5] op_sel_hi:[1,0]
    v_exp_f32 v61, v61
    v_cvt_pk_bf16_f32 v156, v184, v185
    v_exp_f32 v62, v62
    v_cvt_pk_bf16_f32 v157, v186, v187
    v_exp_f32 v63, v63
    v_cvt_pk_bf16_f32 v158, v188, v189
    s_setprio 1
    v_exp_f32 v64, v64
    v_cvt_pk_bf16_f32 v159, v190, v191
    v_exp_f32 v65, v65
    v_smfmac_f32_32x32x32_bf16 v[80:95], v[124:127], v[56:63], v136
    s_add_u32 m0, s54, 94208
    s_add_u32 s4, s55, 2125824
    buffer_load_dwordx4 v3, s[32:35], s4 offen sc1 lds
    v_exp_f32 v66, v66
    v_exp_f32 v67, v67
    buffer_store_dwordx4 v[156:159], v3, s[32:35], s79 offen offset:1024 sc1
    v_exp_f32 v68, v68
    v_exp_f32 v69, v69
    v_exp_f32 v70, v70
    v_mfma_f32_32x32x16_bf16 v[216:231], v[116:119], v[12:15], v[32:47]
    v_exp_f32 v71, v71
    v_exp_f32 v72, v72
    v_exp_f32 v73, v73
    v_exp_f32 v74, v74
    v_exp_f32 v75, v75
    v_smfmac_f32_32x32x32_bf16 v[96:111], v[120:123], v[64:71], v136
    s_mov_b64 exec, s[14:15]
    ds_read_b128 v[128:131], v138 offset:21504
    ds_read_b128 v[132:135], v138 offset:22016
    s_mov_b64 exec, -1
    v_exp_f32 v76, v76
    v_exp_f32 v77, v77
    v_exp_f32 v78, v78
    v_exp_f32 v79, v79
    s_branch L_dupret32
L_job_f4:
    v_mov_b32 v4, s36
    s_mov_b64 exec, 1
    buffer_store_dword v4, v3, s[32:35], s67 offen sc1
    s_mov_b64 exec, -1
    s_branch L_ret_f4
L_pollF2_spin:
    v_and_b32 v6, 2047, v139
    s_mov_b32 s7, 200000
    s_branch L_pollF2_cmp
L_pollF2:
    buffer_load_dword v0, v6, s[32:35], s51 offen sc1
L_pollF2_chk:
    s_waitcnt vmcnt(0)
L_pollF2_cmp:
    v_cmp_ne_u32 s[44:45], s36, v0
    s_sub_u32 s7, s7, 1
    s_or_b32 s44, s44, s45
    s_cbranch_scc0 L_pollF2_ok
    s_cmp_eq_u32 s7, 0
    s_cbranch_scc1 L_pollF2_ok
    s_sleep 1
    s_branch L_pollF2
L_pollF2_ok:
    s_branch L_pollF2_back
L_pollF5_spin:
    v_and_b32 v6, 2047, v139
    s_mov_b32 s7, 200000
    s_branch L_pollF5_cmp
L_pollF5:
    buffer_load_dword v2, v6, s[32:35], s77 offen sc1
L_pollF5_chk:
    s_waitcnt vmcnt(0)
L_pollF5_cmp:
    v_cmp_ne_u32 s[44:45], s36, v2
    s_sub_u32 s7, s7, 1
    s_or_b32 s44, s44, s45
    s_cbranch_scc0 L_pollF5_ok
    s_cmp_eq_u32 s7, 0
    s_cbranch_scc1 L_pollF5_ok
    s_sleep 1
    s_branch L_pollF5
L_pollF5_ok:
    s_branch L_pollF5_back
L_pollF4_spin:
    v_and_b32 v6, 2047, v139
    s_mov_b32 s7, 200000
    s_branch L_pollF4_cmp
L_pollF4:
    buffer_load_dword v0, v6, s[32:35], s66 offen sc1
L_pollF4_chk:
    s_waitcnt vmcnt(0)
L_pollF4_cmp:
    v_cmp_ne_u32 s[44:45], s36, v0
    s_sub_u32 s7, s7, 1
    s_or_b32 s44, s44, s45
    s_cbranch_scc0 L_pollF4_ok
    s_cmp_eq_u32 s7, 0
    s_cbranch_scc1 L_pollF4_ok
    s_sleep 1
    s_branch L_pollF4
L_pollF4_ok:
    s_branch L_pollF4_back
L_obad0:
    s_sub_u32 s7, s7, 1
    s_cmp_lt_i32 s7, 1
    s_cbranch_scc1 L_og0
    s_waitcnt vmcnt(0)
    s_sleep 4
    buffer_load_dwordx4 v[224:227], v3, s[32:35], s62 offen offset:0 sc1
    v_max3_u32 v4, v228, v229, v230
    v_max_u32 v4, v4, v231
    v_cmp_eq_u32 vcc, -1, v4
    s_nop 1
    s_cbranch_vccz L_os0_1
    buffer_load_dwordx4 v[228:231], v3, s[32:35], s62 offen offset:1024 sc1
L_os0_1:
    v_max3_u32 v4, v232, v233, v234
    v_max_u32 v4, v4, v235
    v_cmp_eq_u32 vcc, -1, v4
    s_nop 1
    s_cbranch_vccz L_os0_2
    buffer_load_dwordx4 v[232:235], v3, s[32:35], s62 offen offset:2048 sc1
L_os0_2:
    v_max3_u32 v4, v236, v237, v238
    v_max_u32 v4, v4, v239
    v_cmp_eq_u32 vcc, -1, v4
    s_nop 1
    s_cbranch_vccz L_os0_3
    buffer_load_dwordx4 v[236:239], v3, s[32:35], s62 offen offset:3072 sc1
L_os0_3:
    v_max3_u32 v4, v240, v241, v242
    v_max_u32 v4, v4, v243
    v_cmp_eq_u32 vcc, -1, v4
    s_nop 1
    s_cbranch_vccz L_os0_4
    buffer_load_dwordx4 v[240:243], v3, s[32:35], s63 offen offset:0 sc1
L_os0_4:
    s_waitcnt vmcnt(0)
    s_branch L_ot0
L_obad1:
    s_sub_u32 s7, s7, 1
    s_cmp_lt_i32 s7, 1
    s_cbranch_scc1 L_og1
    s_waitcnt vmcnt(0)
    s_sleep 4
    buffer_load_dwordx4 v[228:231], v3, s[32:35], s62 offen offset:1024 sc1
    v_max3_u32 v4, v232, v233, v234
    v_max_u32 v4, v4, v235
    v_cmp_eq_u32 vcc, -1, v4
    s_nop 1
    s_cbranch_vccz L_os1_2
    buffer_load_dwordx4 v[232:235], v3, s[32:35], s62 offen offset:2048 sc1
L_os1_2:
    v_max3_u32 v4, v236, v237, v238
    v_max_u32 v4, v4, v239
    v_cmp_eq_u32 vcc, -1, v4
    s_nop 1
    s_cbranch_vccz L_os1_3
    buffer_load_dwordx4 v[236:239], v3, s[32:35], s62 offen offset:3072 sc1
L_os1_3:
    v_max3_u32 v4, v240, v241, v242
    v_max_u32 v4, v4, v243
    v_cmp_eq_u32 vcc, -1, v4
    s_nop 1
    s_cbranch_vccz L_os1_4
    buffer_load_dwordx4 v[240:243], v3, s[32:35], s63 offen offset:0 sc1
L_os1_4:
    v_max3_u32 v4, v244, v245, v246
    v_max_u32 v4, v4, v247
    v_cmp_eq_u32 vcc, -1, v4
    s_nop 1
    s_cbranch_vccz L_os1_5
    buffer_load_dwordx4 v[244:247], v3, s[32:35], s63 offen offset:1024 sc1
L_os1_5:
    s_waitcnt vmcnt(0)
    s_branch L_ot1
L_obad2:
    s_sub_u32 s7, s7, 1
    s_cmp_lt_i32 s7, 1
    s_cbranch_scc1 L_og2
    s_waitcnt vmcnt(0)
    s_sleep 4
    buffer_load_dwordx4 v[232:235], v3, s[32:35], s62 offen offset:2048 sc1
    v_max3_u32 v4, v236, v237, v238
    v_max_u32 v4, v4, v239
    v_cmp_eq_u32 vcc, -1, v4
    s_nop 1
    s_cbranch_vccz L_os2_3
    buffer_load_dwordx4 v[236:239], v3, s[32:35], s62 offen offset:3072 sc1
L_os2_3:
    v_max3_u32 v4, v240, v241, v242
    v_max_u32 v4, v4, v243
    v_cmp_eq_u32 vcc, -1, v4
    s_nop 1
    s_cbranch_vccz L_os2_4
    buffer_load_dwordx4 v[240:243], v3, s[32:35], s63 offen offset:0 sc1
L_os2_4:
    v_max3_u32 v4, v244, v245, v246
    v_max_u32 v4, v4, v247
    v_cmp_eq_u32 vcc, -1, v4
    s_nop 1
    s_cbranch_vccz L_os2_5
    buffer_load_dwordx4 v[244:247], v3, s[32:35], s63 offen offset:1024 sc1
L_os2_5:
    v_max3_u32 v4, v248, v249, v250
    v_max_u32 v4, v4, v251
    v_cmp_eq_u32 vcc, -1, v4
    s_nop 1
    s_cbranch_vccz L_os2_6
    buffer_load_dwordx4 v[248:251], v3, s[32:35], s63 offen offset:2048 sc1
L_os2_6:
    s_waitcnt vmcnt(0)
    s_branch L_ot2
L_obad3:
    s_sub_u32 s7, s7, 1
    s_cmp_lt_i32 s7, 1
    s_cbranch_scc1 L_og3
    s_waitcnt vmcnt(0)
    s_sleep 4
    buffer_load_dwordx4 v[236:239], v3, s[32:35], s62 offen offset:3072 sc1
    v_max3_u32 v4, v240, v241, v242
    v_max_u32 v4, v4, v243
    v_cmp_eq_u32 vcc, -1, v4
    s_nop 1
    s_cbranch_vccz L_os3_4
    buffer_load_dwordx4 v[240:243], v3, s[32:35], s63 offen offset:0 sc1
L_os3_4:
    v_max3_u32 v4, v244, v245, v246
    v_max_u32 v4, v4, v247
    v_cmp_eq_u32 vcc, -1, v4
    s_nop 1
    s_cbranch_vccz L_os3_5
    buffer_load_dwordx4 v[244:247], v3, s[32:35], s63 offen offset:1024 sc1
L_os3_5:
    v_max3_u32 v4, v248, v249, v250
    v_max_u32 v4, v4, v251
    v_cmp_eq_u32 vcc, -1, v4
    s_nop 1
    s_cbranch_vccz L_os3_6
    buffer_load_dwordx4 v[248:251], v3, s[32:35], s63 offen offset:2048 sc1
L_os3_6:
    v_max3_u32 v4, v252, v253, v254
    v_max_u32 v4, v4, v255
    v_cmp_eq_u32 vcc, -1, v4
    s_nop 1
    s_cbranch_vccz L_os3_7
    buffer_load_dwordx4 v[252:255], v3, s[32:35], s63 offen offset:3072 sc1
L_os3_7:
    s_waitcnt vmcnt(0)
    s_branch L_ot3
L_obad4:
    s_sub_u32 s7, s7, 1
    s_cmp_lt_i32 s7, 1
    s_cbranch_scc1 L_og4
    s_waitcnt vmcnt(0)
    s_sleep 4
    buffer_load_dwordx4 v[240:243], v3, s[32:35], s63 offen offset:0 sc1
    v_max3_u32 v4, v244, v245, v246
    v_max_u32 v4, v4, v247
    v_cmp_eq_u32 vcc, -1, v4
    s_nop 1
    s_cbranch_vccz L_os4_5
    buffer_load_dwordx4 v[244:247], v3, s[32:35], s63 offen offset:1024 sc1
L_os4_5:
    v_max3_u32 v4, v248, v249, v250
    v_max_u32 v4, v4, v251
    v_cmp_eq_u32 vcc, -1, v4
    s_nop 1
    s_cbranch_vccz L_os4_6
    buffer_load_dwordx4 v[248:251], v3, s[32:35], s63 offen offset:2048 sc1
L_os4_6:
    v_max3_u32 v4, v252, v253, v254
    v_max_u32 v4, v4, v255
    v_cmp_eq_u32 vcc, -1, v4
    s_nop 1
    s_cbranch_vccz L_os4_7
    buffer_load_dwordx4 v[252:255], v3, s[32:35], s63 offen offset:3072 sc1
L_os4_7:
    s_waitcnt vmcnt(0)
    s_branch L_ot4
L_obad5:
    s_sub_u32 s7, s7, 1
    s_cmp_lt_i32 s7, 1
    s_cbranch_scc1 L_og5
    s_waitcnt vmcnt(0)
    s_sleep 4
    buffer_load_dwordx4 v[244:247], v3, s[32:35], s63 offen offset:1024 sc1
    v_max3_u32 v4, v248, v249, v250
    v_max_u32 v4, v4, v251
    v_cmp_eq_u32 vcc, -1, v4
    s_nop 1
    s_cbranch_vccz L_os5_6
    buffer_load_dwordx4 v[248:251], v3, s[32:35], s63 offen offset:2048 sc1
L_os5_6:
    v_max3_u32 v4, v252, v253, v254
    v_max_u32 v4, v4, v255
    v_cmp_eq_u32 vcc, -1, v4
    s_nop 1
    s_cbranch_vccz L_os5_7
    buffer_load_dwordx4 v[252:255], v3, s[32:35], s63 offen offset:3072 sc1
L_os5_7:
    s_waitcnt vmcnt(0)
    s_branch L_ot5
L_obad6:
    s_sub_u32 s7, s7, 1
    s_cmp_lt_i32 s7, 1
    s_cbranch_scc1 L_og6
    s_waitcnt vmcnt(0)
    s_sleep 4
    buffer_load_dwordx4 v[248:251], v3, s[32:35], s63 offen offset:2048 sc1
    v_max3_u32 v4, v252, v253, v254
    v_max_u32 v4, v4, v255
    v_cmp_eq_u32 vcc, -1, v4
    s_nop 1
    s_cbranch_vccz L_os6_7
    buffer_load_dwordx4 v[252:255], v3, s[32:35], s63 offen offset:3072 sc1
L_os6_7:
    s_waitcnt vmcnt(0)
    s_branch L_ot6
L_obad7:
    s_sub_u32 s7, s7, 1
    s_cmp_lt_i32 s7, 1
    s_cbranch_scc1 L_og7
    s_waitcnt vmcnt(0)
    s_sleep 4
    buffer_load_dwordx4 v[252:255], v3, s[32:35], s63 offen offset:3072 sc1
    s_waitcnt vmcnt(0)
    s_branch L_ot7
L_maybe_fb:
    s_cmp_lg_u32 s43, 0
    s_cbranch_scc1 L_fin
    s_mov_b32 s43, 1
    s_mov_b32 s59, 0
    s_waitcnt vmcnt(0) lgkmcnt(0)
    s_barrier
    s_add_u32 m0, s54, 0
    s_add_u32 s4, s55, 0
    buffer_load_dwordx4 v3, s[32:35], s4 offen sc1 lds
    s_add_u32 m0, s54, 65536
    s_add_u32 s4, s55, 2097152
    buffer_load_dwordx4 v3, s[32:35], s4 offen sc1 lds
    s_add_u32 m0, s54, 4096
    s_add_u32 s4, s55, 4096
    buffer_load_dwordx4 v3, s[32:35], s4 offen sc1 lds
    s_add_u32 m0, s54, 69632
    s_add_u32 s4, s55, 2101248
    buffer_load_dwordx4 v3, s[32:35], s4 offen sc1 lds
    s_add_u32 m0, s54, 8192
    s_add_u32 s4, s55, 8192
    buffer_load_dwordx4 v3, s[32:35], s4 offen sc1 lds
    s_add_u32 m0, s54, 73728
    s_add_u32 s4, s55, 2105344
    buffer_load_dwordx4 v3, s[32:35], s4 offen sc1 lds
    s_add_u32 m0, s54, 12288
    s_add_u32 s4, s55, 12288
    buffer_load_dwordx4 v3, s[32:35], s4 offen sc1 lds
    s_add_u32 m0, s54, 77824
    s_add_u32 s4, s55, 2109440
    buffer_load_dwordx4 v3, s[32:35], s4 offen sc1 lds
    s_add_u32 m0, s54, 16384
    s_add_u32 s4, s55, 16384
    buffer_load_dwordx4 v3, s[32:35], s4 offen sc1 lds
    s_add_u32 m0, s54, 81920
    s_add_u32 s4, s55, 2113536
    buffer_load_dwordx4 v3, s[32:35], s4 offen sc1 lds
    s_add_u32 m0, s54, 20480
    s_add_u32 s4, s55, 20480
    buffer_load_dwordx4 v3, s[32:35], s4 offen sc1 lds
    s_add_u32 m0, s54, 86016
    s_add_u32 s4, s55, 2117632
    buffer_load_dwordx4 v3, s[32:35], s4 offen sc1 lds
    s_add_u32 m0, s54, 24576
    s_add_u32 s4, s55, 24576
    buffer_load_dwordx4 v3, s[32:35], s4 offen sc1 lds
    s_add_u32 m0, s54, 90112
    s_add_u32 s4, s55, 2121728
    buffer_load_dwordx4 v3, s[32:35], s4 offen sc1 lds
    s_add_u32 m0, s54, 28672
    s_add_u32 s4, s55, 28672
    buffer_load_dwordx4 v3, s[32:35], s4 offen sc1 lds
    s_add_u32 m0, s54, 94208
    s_add_u32 s4, s55, 2125824
    buffer_load_dwordx4 v3, s[32:35], s4 offen sc1 lds
    v_mov_b32 v150, 0xff800000
    v_mov_b32 v151, 0xff800000
    v_mov_b32 v4, v3
    s_mov_b32 s7, 64
    s_waitcnt vmcnt(0)
    s_barrier
L_fbloop:
    ds_read_b128 v[112:115], v4
    v_add_u32 v4, 1024, v4
    s_waitcnt lgkmcnt(0)
    v_mfma_f32_32x32x16_bf16 v[48:63], v[112:115], v[8:11], 0
    v_mfma_f32_32x32x16_bf16 v[64:79], v[112:115], v[12:15], 0
    s_nop 11
    v_max3_f32 v150, v150, v48, v49
    v_max3_f32 v150, v150, v50, v51
    v_max3_f32 v150, v150, v52, v53
    v_max3_f32 v150, v150, v54, v55
    v_max3_f32 v150, v150, v56, v57
    v_max3_f32 v150, v150, v58, v59
    v_max3_f32 v150, v150, v60, v61
    v_max3_f32 v150, v150, v62, v63
    v_max3_f32 v151, v151, v64, v65
    v_max3_f32 v151, v151, v66, v67
    v_max3_f32 v151, v151, v68, v69
    v_max3_f32 v151, v151, v70, v71
    v_max3_f32 v151, v151, v72, v73
    v_max3_f32 v151, v151, v74, v75
    v_max3_f32 v151, v151, v76, v77
    v_max3_f32 v151, v151, v78, v79
    s_sub_u32 s7, s7, 1
    s_cmp_lg_u32 s7, 0
    s_cbranch_scc1 L_fbloop
    v_mov_b64 v[80:81], 0
    v_mov_b64 v[82:83], 0
    v_mov_b64 v[84:85], 0
    v_mov_b64 v[86:87], 0
    v_mov_b64 v[88:89], 0
    v_mov_b64 v[90:91], 0
    v_mov_b64 v[92:93], 0
    v_mov_b64 v[94:95], 0
    v_mov_b64 v[96:97], 0
    v_mov_b64 v[98:99], 0
    v_mov_b64 v[100:101], 0
    v_mov_b64 v[102:103], 0
    v_mov_b64 v[104:105], 0
    v_mov_b64 v[106:107], 0
    v_mov_b64 v[108:109], 0
    v_mov_b64 v[110:111], 0
    ds_read_b128 v[112:115], v137
    ds_read_b128 v[116:119], v137 offset:1024
    s_mov_b64 exec, s[14:15]
    ds_read_b128 v[120:123], v138
    ds_read_b128 v[124:127], v138 offset:512
    s_mov_b64 exec, -1
    v_permlane32_swap_b32 v150, v151
    v_max_f32 v150, v150, v151
    v_sub_f32 v150, 0, v150
    v_mov_b32 v151, v150
    s_nop 1
    v_permlane32_swap_b32 v150, v151
    v_pk_mov_b32 v[16:17], v[150:151], v[150:151] op_sel:[0,0]
    v_pk_mov_b32 v[18:19], v[150:151], v[150:151] op_sel:[0,0]
    v_pk_mov_b32 v[20:21], v[150:151], v[150:151] op_sel:[0,0]
    v_pk_mov_b32 v[22:23], v[150:151], v[150:151] op_sel:[0,0]
    v_pk_mov_b32 v[24:25], v[150:151], v[150:151] op_sel:[0,0]
    v_pk_mov_b32 v[26:27], v[150:151], v[150:151] op_sel:[0,0]
    v_pk_mov_b32 v[28:29], v[150:151], v[150:151] op_sel:[0,0]
    v_pk_mov_b32 v[30:31], v[150:151], v[150:151] op_sel:[0,0]
    v_pk_mov_b32 v[32:33], v[150:151], v[150:151] op_sel:[1,1]
    v_pk_mov_b32 v[34:35], v[150:151], v[150:151] op_sel:[1,1]
    v_pk_mov_b32 v[36:37], v[150:151], v[150:151] op_sel:[1,1]
    v_pk_mov_b32 v[38:39], v[150:151], v[150:151] op_sel:[1,1]
    v_pk_mov_b32 v[40:41], v[150:151], v[150:151] op_sel:[1,1]
    v_pk_mov_b32 v[42:43], v[150:151], v[150:151] op_sel:[1,1]
    v_pk_mov_b32 v[44:45], v[150:151], v[150:151] op_sel:[1,1]
    v_pk_mov_b32 v[46:47], v[150:151], v[150:151] op_sel:[1,1]
    s_nop 1
    s_branch L_redo
L_code_end:
    s_endpgm
.section .rodata,"a"
.p2align 6
.amdhsa_kernel gated_mix__linear_kernel_hedgehog__mha_block__prompt_kernel
  .amdhsa_next_free_vgpr 256
  .amdhsa_next_free_sgpr 102
  .amdhsa_accum_offset 256
  .amdhsa_group_segment_fixed_size 0
  .amdhsa_kernarg_size 88
  .amdhsa_user_sgpr_count 2
  .amdhsa_user_sgpr_kernarg_segment_ptr 1
  .amdhsa_system_sgpr_workgroup_id_x 1
.end_amdhsa_kernel
.p2align 8
L_vtab:
.long 0,32,64,96,128,160,192,224
.long 272,304,336,368,400,432,464,496
.long 544,512,608,576,672,640,736,704
.long 816,784,880,848,944,912,1008,976
.long 1088,1120,1024,1056,1216,1248,1152,1184
.long 1360,1392,1296,1328,1488,1520,1424,1456
.long 1632,1600,1568,1536,1760,1728,1696,1664
.long 1904,1872,1840,1808,2032,2000,1968,1936
.long 2048,2080,2112,2144,2176,2208,2240,2272
.long 2320,2352,2384,2416,2448,2480,2512,2544
.long 2592,2560,2656,2624,2720,2688,2784,2752
.long 2864,2832,2928,2896,2992,2960,3056,3024
.long 3136,3168,3072,3104,3264,3296,3200,3232
.long 3408,3440,3344,3376,3536,3568,3472,3504
.long 3680,3648,3616,3584,3808,3776,3744,3712
.long 3952,3920,3888,3856,4080,4048,4016,3984
.long 16,48,80,112,144,176,208,240
.long 256,288,320,352,384,416,448,480
.long 560,528,624,592,688,656,752,720
.long 800,768,864,832,928,896,992,960
.long 1104,1136,1040,1072,1232,1264,1168,1200
.long 1344,1376,1280,1312,1472,1504,1408,1440
.long 1648,1616,1584,1552,1776,1744,1712,1680
.long 1888,1856,1824,1792,2016,1984,1952,1920
.long 2064,2096,2128,2160,2192,2224,2256,2288
.long 2304,2336,2368,2400,2432,2464,2496,2528
.long 2608,2576,2672,2640,2736,2704,2800,2768
.long 2848,2816,2912,2880,2976,2944,3040,3008
.long 3152,3184,3088,3120,3280,3312,3216,3248
.long 3392,3424,3328,3360,3520,3552,3456,3488
.long 3696,3664,3632,3600,3824,3792,3760,3728
.long 3936,3904,3872,3840,4064,4032,4000,3968
.long 16384,81920,8192,131072,16392,81928,8200,131080
.long 16400,81936,8208,131088,16408,81944,8216,131096
.long 16512,82048,8224,131200,16520,82056,8232,131208
.long 16528,82064,8240,131216,16536,82072,8248,131224
.long 16704,82240,8256,131392,16712,82248,8264,131400
.long 16720,82256,8272,131408,16728,82264,8280,131416
.long 16832,82368,8288,131520,16840,82376,8296,131528
.long 16848,82384,8304,131536,16856,82392,8312,131544
.long 16416,81952,8192,131104,16424,81960,8200,131112
.long 16432,81968,8208,131120,16440,81976,8216,131128
.long 16544,82080,8224,131232,16552,82088,8232,131240
.long 16560,82096,8240,131248,16568,82104,8248,131256
.long 16736,82272,8256,131424,16744,82280,8264,131432
.long 16752,82288,8272,131440,16760,82296,8280,131448
.long 16864,82400,8288,131552,16872,82408,8296,131560
.long 16880,82416,8304,131568,16888,82424,8312,131576
.long 18432,83968,8320,132096,18440,83976,8328,132104
.long 18448,83984,8336,132112,18456,83992,8344,132120
.long 18560,84096,8352,132224,18568,84104,8360,132232
.long 18576,84112,8368,132240,18584,84120,8376,132248
.long 18752,84288,8384,132416,18760,84296,8392,132424
.long 18768,84304,8400,132432,18776,84312,8408,132440
.long 18880,84416,8416,132544,18888,84424,8424,132552
.long 18896,84432,8432,132560,18904,84440,8440,132568
.long 18464,84000,8320,132128,18472,84008,8328,132136
.long 18480,84016,8336,132144,18488,84024,8344,132152
.long 18592,84128,8352,132256,18600,84136,8360,132264
.long 18608,84144,8368,132272,18616,84152,8376,132280
.long 18784,84320,8384,132448,18792,84328,8392,132456
.long 18800,84336,8400,132464,18808,84344,8408,132472
.long 18912,84448,8416,132576,18920,84456,8424,132584
.long 18928,84464,8432,132592,18936,84472,8440,132600
.long 0,0,8192,8192,16,16,8208,8208
.long 32,32,8224,8224,48,48,8240,8240
.long 128,64,8256,8256,144,80,8272,8272
.long 160,96,8288,8288,176,112,8304,8304
.long 64,128,8320,8320,80,144,8336,8336
.long 96,160,8352,8352,112,176,8368,8368
.long 192,192,8384,8384,208,208,8400,8400
.long 224,224,8416,8416,240,240,8432,8432
.long 256,65536,8448,8448,272,65552,8464,8464
.long 288,65568,8480,8480,304,65584,8496,8496
.long 384,65600,8512,8512,400,65616,8528,8528
.long 416,65632,8544,8544,432,65648,8560,8560
.long 320,65664,8576,8576,336,65680,8592,8592
.long 352,65696,8608,8608,368,65712,8624,8624
.long 448,65728,8640,8640,464,65744,8656,8656
.long 480,65760,8672,8672,496,65776,8688,8688
.long 512,256,8704,8704,528,272,8720,8720
.long 544,288,8736,8736,560,304,8752,8752
.long 640,320,8768,8768,656,336,8784,8784
.long 672,352,8800,8800,688,368,8816,8816
.long 576,384,8832,8832,592,400,8848,8848
.long 608,416,8864,8864,624,432,8880,8880
.long 704,448,8896,8896,720,464,8912,8912
.long 736,480,8928,8928,752,496,8944,8944
.long 768,65792,8960,8960,784,65808,8976,8976
.long 800,65824,8992,8992,816,65840,9008,9008
.long 896,65856,9024,9024,912,65872,9040,9040
.long 928,65888,9056,9056,944,65904,9072,9072
.long 832,65920,9088,9088,848,65936,9104,9104
.long 864,65952,9120,9120,880,65968,9136,9136
.long 960,65984,9152,9152,976,66000,9168,9168
.long 992,66016,9184,9184,1008,66032,9200,9200
.long 0,512,0,0,16,528,0,0
.long 32,544,0,0,48,560,0,0
.long 64,576,0,0,80,592,0,0
.long 96,608,0,0,112,624,0,0
.long 128,640,0,0,144,656,0,0
.long 160,672,0,0,176,688,0,0
.long 192,704,0,0,208,720,0,0
.long 224,736,0,0,240,752,0,0
.long 2048,2080,1065369472,1065369472,2048,2080,0,0
.long 2048,2080,0,0,2048,2080,0,0
.long 2048,2080,1065369472,1065369472,2048,2080,0,0
.long 2048,2080,0,0,2048,2080,0,0
.long 2048,2080,0,0,2048,2080,0,0
.long 2048,2080,0,0,2048,2080,0,0
.long 2048,2080,0,0,2048,2080,0,0
.long 2048,2080,0,0,2048,2080,0,0
.long 256,768,0,0,272,784,0,0
.long 288,800,0,0,304,816,0,0
.long 320,832,0,0,336,848,0,0
.long 352,864,0,0,368,880,0,0
.long 384,896,0,0,400,912,0,0
.long 416,928,0,0,432,944,0,0
.long 448,960,0,0,464,976,0,0
.long 480,992,0,0,496,1008,0,0
.long 2064,2096,1065369472,1065369472,2064,2096,0,0
.long 2064,2096,0,0,2064,2096,0,0
.long 2064,2096,1065369472,1065369472,2064,2096,0,0
.long 2064,2096,0,0,2064,2096,0,0
.long 2064,2096,0,0,2064,2096,0,0
.long 2064,2096,0,0,2064,2096,0,0
.long 2064,2096,0,0,2064,2096,0,0
.long 2064,2096,0,0,2064,2096,0,0
.long 16256,0,0,0,1065353216,0,0,0
.long 0,16256,0,0,0,1065353216,0,0
.long 0,0,0,0,0,0,0,0
.long 0,0,0,0,0,0,0,0
.long 0,0,16256,0,0,0,1065353216,0
.long 0,0,0,16256,0,0,0,1065353216
.long 0,0,0,0,0,0,0,0
.long 0,0,0,0,0,0,0,0
.long 0,0,0,0,0,0,0,0
.long 0,0,0,0,0,0,0,0
.long 0,0,0,0,0,0,0,0
.long 0,0,0,0,0,0,0,0
.long 0,0,0,0,0,0,0,0
.long 0,0,0,0,0,0,0,0
.long 0,0,0,0,0,0,0,0
.long 0,0,0,0,0,0,0,0
.long 0,0,0,0,0,0,0,0
.long 0,0,0,0,0,0,0,0
.long 16256,0,0,0,1065353216,0,0,0
.long 0,16256,0,0,0,1065353216,0,0
.long 0,0,0,0,0,0,0,0
.long 0,0,0,0,0,0,0,0
.long 0,0,16256,0,0,0,1065353216,0
.long 0,0,0,16256,0,0,0,1065353216
.long 0,0,0,0,0,0,0,0
.long 0,0,0,0,0,0,0,0
.long 0,0,0,0,0,0,0,0
.long 0,0,0,0,0,0,0,0
.long 0,0,0,0,0,0,0,0
.long 0,0,0,0,0,0,0,0
.long 0,0,0,0,0,0,0,0
.long 0,0,0,0,0,0,0,0
.long 0,0,0,0,0,0,0,0
.long 0,0,0,0,0,0,0,0
.long 0,0,0,0,0,0,0,0
.long 0,0,0,0,0,0,0,0
.long 0,0,0,0,0,0,0,0
.long 0,0,0,0,0,0,0,0
.long 0,0,0,0,0,0,0,0
.long 0,0,0,0,0,0,0,0
.long 16256,0,0,0,1065353216,0,0,0
.long 0,16256,0,0,0,1065353216,0,0
.long 0,0,0,0,0,0,0,0
.long 0,0,0,0,0,0,0,0
.long 0,0,16256,0,0,0,1065353216,0
.long 0,0,0,16256,0,0,0,1065353216
.long 0,0,0,0,0,0,0,0
.long 0,0,0,0,0,0,0,0
.long 0,0,0,0,0,0,0,0
.long 0,0,0,0,0,0,0,0
.long 0,0,0,0,0,0,0,0
.long 0,0,0,0,0,0,0,0
.long 0,0,0,0,0,0,0,0
.long 0,0,0,0,0,0,0,0
.long 0,0,0,0,0,0,0,0
.long 0,0,0,0,0,0,0,0
.long 0,0,0,0,0,0,0,0
.long 0,0,0,0,0,0,0,0
.long 16256,0,0,0,1065353216,0,0,0
.long 0,16256,0,0,0,1065353216,0,0
.long 0,0,0,0,0,0,0,0
.long 0,0,0,0,0,0,0,0
.long 0,0,16256,0,0,0,1065353216,0
.long 0,0,0,16256,0,0,0,1065353216
.long 0,131072,143360,0,16,131088,143376,8
.long 32,131104,143392,16,48,131120,143408,24
.long 64,131136,143424,128,80,131152,143440,136
.long 96,131168,143456,144,112,131184,143472,152
.long 1024,131200,143488,320,1040,131216,143504,328
.long 1056,131232,143520,336,1072,131248,143536,344
.long 1088,131264,143552,448,1104,131280,143568,456
.long 1120,131296,143584,464,1136,131312,143600,472
.long 2112,131328,143616,32,2128,131344,143632,40
.long 2144,131360,143648,48,2160,131376,143664,56
.long 2048,131392,143680,160,2064,131408,143696,168
.long 2080,131424,143712,176,2096,131440,143728,184
.long 3136,131456,143744,352,3152,131472,143760,360
.long 3168,131488,143776,368,3184,131504,143792,376
.long 3072,131520,143808,480,3088,131536,143824,488
.long 3104,131552,143840,496,3120,131568,143856,504
.long 4096,131584,143872,512,4112,131600,143888,520
.long 4128,131616,143904,528,4144,131632,143920,536
.long 4160,131648,143936,640,4176,131664,143952,648
.long 4192,131680,143968,656,4208,131696,143984,664
.long 5120,131712,144000,832,5136,131728,144016,840
.long 5152,131744,144032,848,5168,131760,144048,856
.long 5184,131776,144064,960,5200,131792,144080,968
.long 5216,131808,144096,976,5232,131824,144112,984
.long 6208,131840,144128,544,6224,131856,144144,552
.long 6240,131872,144160,560,6256,131888,144176,568
.long 6144,131904,144192,672,6160,131920,144208,680
.long 6176,131936,144224,688,6192,131952,144240,696
.long 7232,131968,144256,864,7248,131984,144272,872
.long 7264,132000,144288,880,7280,132016,144304,888
.long 7168,132032,144320,992,7184,132048,144336,1000
.long 7200,132064,144352,1008,7216,132080,144368,1016
.long 64,0,0,0,72,16,1024,4
.long 80,32,2048,8,88,48,3072,12
.long 192,64,4096,16,200,80,5120,20
.long 208,96,6144,24,216,112,7168,28
.long 256,128,8192,32,264,144,9216,36
.long 272,160,10240,40,280,176,11264,44
.long 384,192,12288,48,392,208,13312,52
.long 400,224,14336,56,408,240,15360,60
.long 96,256,16384,64,104,272,17408,68
.long 112,288,18432,72,120,304,19456,76
.long 224,320,20480,80,232,336,21504,84
.long 240,352,22528,88,248,368,23552,92
.long 288,384,24576,96,296,400,25600,100
.long 304,416,26624,104,312,432,27648,108
.long 416,448,28672,112,424,464,29696,116
.long 432,480,30720,120,440,496,31744,124
.long 576,512,16,0,584,528,1040,4
.long 592,544,2064,8,600,560,3088,12
.long 704,576,4112,16,712,592,5136,20
.long 720,608,6160,24,728,624,7184,28
.long 768,640,8208,32,776,656,9232,36
.long 784,672,10256,40,792,688,11280,44
.long 896,704,12304,48,904,720,13328,52
.long 912,736,14352,56,920,752,15376,60
.long 608,768,16400,64,616,784,17424,68
.long 624,800,18448,72,632,816,19472,76
.long 736,832,20496,80,744,848,21520,84
.long 752,864,22544,88,760,880,23568,92
.long 800,896,24592,96,808,912,25616,100
.long 816,928,26640,104,824,944,27664,108
.long 928,960,28688,112,936,976,29712,116
.long 944,992,30736,120,952,1008,31760,124
.long 4096,4128,4160,4192,4224,4256,4288,4320
.long 4368,4400,4432,4464,4496,4528,4560,4592
.long 4640,4608,4704,4672,4768,4736,4832,4800
.long 4912,4880,4976,4944,5040,5008,5104,5072
.long 5184,5216,5120,5152,5312,5344,5248,5280
.long 5456,5488,5392,5424,5584,5616,5520,5552
.long 5728,5696,5664,5632,5856,5824,5792,5760
.long 6000,5968,5936,5904,6128,6096,6064,6032
.long 6144,6176,6208,6240,6272,6304,6336,6368
.long 6416,6448,6480,6512,6544,6576,6608,6640
.long 6688,6656,6752,6720,6816,6784,6880,6848
.long 6960,6928,7024,6992,7088,7056,7152,7120
.long 7232,7264,7168,7200,7360,7392,7296,7328
.long 7504,7536,7440,7472,7632,7664,7568,7600
.long 7776,7744,7712,7680,7904,7872,7840,7808
.long 8048,8016,7984,7952,8176,8144,8112,8080
.long 4112,4144,4176,4208,4240,4272,4304,4336
.long 4352,4384,4416,4448,4480,4512,4544,4576
.long 4656,4624,4720,4688,4784,4752,4848,4816
.long 4896,4864,4960,4928,5024,4992,5088,5056
.long 5200,5232,5136,5168,5328,5360,5264,5296
.long 5440,5472,5376,5408,5568,5600,5504,5536
.long 5744,5712,5680,5648,5872,5840,5808,5776
.long 5984,5952,5920,5888,6112,6080,6048,6016
.long 6160,6192,6224,6256,6288,6320,6352,6384
.long 6400,6432,6464,6496,6528,6560,6592,6624
.long 6704,6672,6768,6736,6832,6800,6896,6864
.long 6944,6912,7008,6976,7072,7040,7136,7104
.long 7248,7280,7184,7216,7376,7408,7312,7344
.long 7488,7520,7424,7456,7616,7648,7552,7584
.long 7792,7760,7728,7696,7920,7888,7856,7824
.long 8032,8000,7968,7936,8160,8128,8096,8064
.long 16384,81920,8192,131072,16392,81928,8200,131080
.long 16400,81936,8208,131088,16408,81944,8216,131096
.long 16512,82048,8224,131200,16520,82056,8232,131208
.long 16528,82064,8240,131216,16536,82072,8248,131224
.long 16704,82240,8256,131392,16712,82248,8264,131400
.long 16720,82256,8272,131408,16728,82264,8280,131416
.long 16832,82368,8288,131520,16840,82376,8296,131528
.long 16848,82384,8304,131536,16856,82392,8312,131544
.long 16416,81952,8192,131104,16424,81960,8200,131112
.long 16432,81968,8208,131120,16440,81976,8216,131128
.long 16544,82080,8224,131232,16552,82088,8232,131240
.long 16560,82096,8240,131248,16568,82104,8248,131256
.long 16736,82272,8256,131424,16744,82280,8264,131432
.long 16752,82288,8272,131440,16760,82296,8280,131448
.long 16864,82400,8288,131552,16872,82408,8296,131560
.long 16880,82416,8304,131568,16888,82424,8312,131576
.long 18432,83968,8320,132096,18440,83976,8328,132104
.long 18448,83984,8336,132112,18456,83992,8344,132120
.long 18560,84096,8352,132224,18568,84104,8360,132232
.long 18576,84112,8368,132240,18584,84120,8376,132248
.long 18752,84288,8384,132416,18760,84296,8392,132424
.long 18768,84304,8400,132432,18776,84312,8408,132440
.long 18880,84416,8416,132544,18888,84424,8424,132552
.long 18896,84432,8432,132560,18904,84440,8440,132568
.long 18464,84000,8320,132128,18472,84008,8328,132136
.long 18480,84016,8336,132144,18488,84024,8344,132152
.long 18592,84128,8352,132256,18600,84136,8360,132264
.long 18608,84144,8368,132272,18616,84152,8376,132280
.long 18784,84320,8384,132448,18792,84328,8392,132456
.long 18800,84336,8400,132464,18808,84344,8408,132472
.long 18912,84448,8416,132576,18920,84456,8424,132584
.long 18928,84464,8432,132592,18936,84472,8440,132600
.long 0,0,16384,10240,16,16,16400,10256
.long 32,32,16416,10272,48,48,16432,10288
.long 128,64,16448,10304,144,80,16464,10320
.long 160,96,16480,10336,176,112,16496,10352
.long 64,128,16512,10368,80,144,16528,10384
.long 96,160,16544,10400,112,176,16560,10416
.long 192,192,16576,10432,208,208,16592,10448
.long 224,224,16608,10464,240,240,16624,10480
.long 256,65536,16640,10496,272,65552,16656,10512
.long 288,65568,16672,10528,304,65584,16688,10544
.long 384,65600,16704,10560,400,65616,16720,10576
.long 416,65632,16736,10592,432,65648,16752,10608
.long 320,65664,16768,10624,336,65680,16784,10640
.long 352,65696,16800,10656,368,65712,16816,10672
.long 448,65728,16832,10688,464,65744,16848,10704
.long 480,65760,16864,10720,496,65776,16880,10736
.long 512,256,16896,10752,528,272,16912,10768
.long 544,288,16928,10784,560,304,16944,10800
.long 640,320,16960,10816,656,336,16976,10832
.long 672,352,16992,10848,688,368,17008,10864
.long 576,384,17024,10880,592,400,17040,10896
.long 608,416,17056,10912,624,432,17072,10928
.long 704,448,17088,10944,720,464,17104,10960
.long 736,480,17120,10976,752,496,17136,10992
.long 768,65792,17152,11008,784,65808,17168,11024
.long 800,65824,17184,11040,816,65840,17200,11056
.long 896,65856,17216,11072,912,65872,17232,11088
.long 928,65888,17248,11104,944,65904,17264,11120
.long 832,65920,17280,11136,848,65936,17296,11152
.long 864,65952,17312,11168,880,65968,17328,11184
.long 960,65984,17344,11200,976,66000,17360,11216
.long 992,66016,17376,11232,1008,66032,17392,11248
.long 1024,1536,0,0,1040,1552,0,0
.long 1056,1568,0,0,1072,1584,0,0
.long 1088,1600,0,0,1104,1616,0,0
.long 1120,1632,0,0,1136,1648,0,0
.long 1152,1664,0,0,1168,1680,0,0
.long 1184,1696,0,0,1200,1712,0,0
.long 1216,1728,0,0,1232,1744,0,0
.long 1248,1760,0,0,1264,1776,0,0
.long 2112,2144,1065369472,1065369472,2112,2144,0,0
.long 2112,2144,0,0,2112,2144,0,0
.long 2112,2144,1065369472,1065369472,2112,2144,0,0
.long 2112,2144,0,0,2112,2144,0,0
.long 2112,2144,0,0,2112,2144,0,0
.long 2112,2144,0,0,2112,2144,0,0
.long 2112,2144,0,0,2112,2144,0,0
.long 2112,2144,0,0,2112,2144,0,0
.long 1280,1792,0,0,1296,1808,0,0
.long 1312,1824,0,0,1328,1840,0,0
.long 1344,1856,0,0,1360,1872,0,0
.long 1376,1888,0,0,1392,1904,0,0
.long 1408,1920,0,0,1424,1936,0,0
.long 1440,1952,0,0,1456,1968,0,0
.long 1472,1984,0,0,1488,2000,0,0
.long 1504,2016,0,0,1520,2032,0,0
.long 2128,2160,1065369472,1065369472,2128,2160,0,0
.long 2128,2160,0,0,2128,2160,0,0
.long 2128,2160,1065369472,1065369472,2128,2160,0,0
.long 2128,2160,0,0,2128,2160,0,0
.long 2128,2160,0,0,2128,2160,0,0
.long 2128,2160,0,0,2128,2160,0,0
.long 2128,2160,0,0,2128,2160,0,0
.long 2128,2160,0,0,2128,2160,0,0
.long 16256,0,0,0,1065353216,0,0,0
.long 0,16256,0,0,0,1065353216,0,0
.long 0,0,0,0,0,0,0,0
.long 0,0,0,0,0,0,0,0
.long 0,0,16256,0,0,0,1065353216,0
.long 0,0,0,16256,0,0,0,1065353216
.long 0,0,0,0,0,0,0,0
.long 0,0,0,0,0,0,0,0
.long 0,0,0,0,0,0,0,0
.long 0,0,0,0,0,0,0,0
.long 0,0,0,0,0,0,0,0
.long 0,0,0,0,0,0,0,0
.long 0,0,0,0,0,0,0,0
.long 0,0,0,0,0,0,0,0
.long 0,0,0,0,0,0,0,0
.long 0,0,0,0,0,0,0,0
.long 0,0,0,0,0,0,0,0
.long 0,0,0,0,0,0,0,0
.long 16256,0,0,0,1065353216,0,0,0
.long 0,16256,0,0,0,1065353216,0,0
.long 0,0,0,0,0,0,0,0
.long 0,0,0,0,0,0,0,0
.long 0,0,16256,0,0,0,1065353216,0
.long 0,0,0,16256,0,0,0,1065353216
.long 0,0,0,0,0,0,0,0
.long 0,0,0,0,0,0,0,0
.long 0,0,0,0,0,0,0,0
.long 0,0,0,0,0,0,0,0
.long 0,0,0,0,0,0,0,0
.long 0,0,0,0,0,0,0,0
.long 0,0,0,0,0,0,0,0
.long 0,0,0,0,0,0,0,0
.long 0,0,0,0,0,0,0,0
.long 0,0,0,0,0,0,0,0
.long 0,0,0,0,0,0,0,0
.long 0,0,0,0,0,0,0,0
.long 0,0,0,0,0,0,0,0
.long 0,0,0,0,0,0,0,0
.long 0,0,0,0,0,0,0,0
.long 0,0,0,0,0,0,0,0
.long 16256,0,0,0,1065353216,0,0,0
.long 0,16256,0,0,0,1065353216,0,0
.long 0,0,0,0,0,0,0,0
.long 0,0,0,0,0,0,0,0
.long 0,0,16256,0,0,0,1065353216,0
.long 0,0,0,16256,0,0,0,1065353216
.long 0,0,0,0,0,0,0,0
.long 0,0,0,0,0,0,0,0
.long 0,0,0,0,0,0,0,0
.long 0,0,0,0,0,0,0,0
.long 0,0,0,0,0,0,0,0
.long 0,0,0,0,0,0,0,0
.long 0,0,0,0,0,0,0,0
.long 0,0,0,0,0,0,0,0
.long 0,0,0,0,0,0,0,0
.long 0,0,0,0,0,0,0,0
.long 0,0,0,0,0,0,0,0
.long 0,0,0,0,0,0,0,0
.long 16256,0,0,0,1065353216,0,0,0
.long 0,16256,0,0,0,1065353216,0,0
.long 0,0,0,0,0,0,0,0
.long 0,0,0,0,0,0,0,0
.long 0,0,16256,0,0,0,1065353216,0
.long 0,0,0,16256,0,0,0,1065353216
.long 0,134144,146432,0,16,134160,146448,8
.long 32,134176,146464,16,48,134192,146480,24
.long 64,134208,146496,128,80,134224,146512,136
.long 96,134240,146528,144,112,134256,146544,152
.long 1024,134272,146560,320,1040,134288,146576,328
.long 1056,134304,146592,336,1072,134320,146608,344
.long 1088,134336,146624,448,1104,134352,146640,456
.long 1120,134368,146656,464,1136,134384,146672,472
.long 2112,134400,146688,32,2128,134416,146704,40
.long 2144,134432,146720,48,2160,134448,146736,56
.long 2048,134464,146752,160,2064,134480,146768,168
.long 2080,134496,146784,176,2096,134512,146800,184
.long 3136,134528,146816,352,3152,134544,146832,360
.long 3168,134560,146848,368,3184,134576,146864,376
.long 3072,134592,146880,480,3088,134608,146896,488
.long 3104,134624,146912,496,3120,134640,146928,504
.long 4096,134656,146944,512,4112,134672,146960,520
.long 4128,134688,146976,528,4144,134704,146992,536
.long 4160,134720,147008,640,4176,134736,147024,648
.long 4192,134752,147040,656,4208,134768,147056,664
.long 5120,134784,147072,832,5136,134800,147088,840
.long 5152,134816,147104,848,5168,134832,147120,856
.long 5184,134848,147136,960,5200,134864,147152,968
.long 5216,134880,147168,976,5232,134896,147184,984
.long 6208,134912,147200,544,6224,134928,147216,552
.long 6240,134944,147232,560,6256,134960,147248,568
.long 6144,134976,147264,672,6160,134992,147280,680
.long 6176,135008,147296,688,6192,135024,147312,696
.long 7232,135040,147328,864,7248,135056,147344,872
.long 7264,135072,147360,880,7280,135088,147376,888
.long 7168,135104,147392,992,7184,135120,147408,1000
.long 7200,135136,147424,1008,7216,135152,147440,1016
.long 64,8192,0,0,72,8208,1024,4
.long 80,8224,2048,8,88,8240,3072,12
.long 192,8256,4096,16,200,8272,5120,20
.long 208,8288,6144,24,216,8304,7168,28
.long 256,8320,8192,32,264,8336,9216,36
.long 272,8352,10240,40,280,8368,11264,44
.long 384,8384,12288,48,392,8400,13312,52
.long 400,8416,14336,56,408,8432,15360,60
.long 96,8448,16384,64,104,8464,17408,68
.long 112,8480,18432,72,120,8496,19456,76
.long 224,8512,20480,80,232,8528,21504,84
.long 240,8544,22528,88,248,8560,23552,92
.long 288,8576,24576,96,296,8592,25600,100
.long 304,8608,26624,104,312,8624,27648,108
.long 416,8640,28672,112,424,8656,29696,116
.long 432,8672,30720,120,440,8688,31744,124
.long 576,8704,16,0,584,8720,1040,4
.long 592,8736,2064,8,600,8752,3088,12
.long 704,8768,4112,16,712,8784,5136,20
.long 720,8800,6160,24,728,8816,7184,28
.long 768,8832,8208,32,776,8848,9232,36
.long 784,8864,10256,40,792,8880,11280,44
.long 896,8896,12304,48,904,8912,13328,52
.long 912,8928,14352,56,920,8944,15376,60
.long 608,8960,16400,64,616,8976,17424,68
.long 624,8992,18448,72,632,9008,19472,76
.long 736,9024,20496,80,744,9040,21520,84
.long 752,9056,22544,88,760,9072,23568,92
.long 800,9088,24592,96,808,9104,25616,100
.long 816,9120,26640,104,824,9136,27664,108
.long 928,9152,28688,112,936,9168,29712,116
.long 944,9184,30736,120,952,9200,31760,124
.long 8192,8224,8256,8288,8320,8352,8384,8416
.long 8464,8496,8528,8560,8592,8624,8656,8688
.long 8736,8704,8800,8768,8864,8832,8928,8896
.long 9008,8976,9072,9040,9136,9104,9200,9168
.long 9280,9312,9216,9248,9408,9440,9344,9376
.long 9552,9584,9488,9520,9680,9712,9616,9648
.long 9824,9792,9760,9728,9952,9920,9888,9856
.long 10096,10064,10032,10000,10224,10192,10160,10128
.long 10240,10272,10304,10336,10368,10400,10432,10464
.long 10512,10544,10576,10608,10640,10672,10704,10736
.long 10784,10752,10848,10816,10912,10880,10976,10944
.long 11056,11024,11120,11088,11184,11152,11248,11216
.long 11328,11360,11264,11296,11456,11488,11392,11424
.long 11600,11632,11536,11568,11728,11760,11664,11696
.long 11872,11840,11808,11776,12000,11968,11936,11904
.long 12144,12112,12080,12048,12272,12240,12208,12176
.long 8208,8240,8272,8304,8336,8368,8400,8432
.long 8448,8480,8512,8544,8576,8608,8640,8672
.long 8752,8720,8816,8784,8880,8848,8944,8912
.long 8992,8960,9056,9024,9120,9088,9184,9152
.long 9296,9328,9232,9264,9424,9456,9360,9392
.long 9536,9568,9472,9504,9664,9696,9600,9632
.long 9840,9808,9776,9744,9968,9936,9904,9872
.long 10080,10048,10016,9984,10208,10176,10144,10112
.long 10256,10288,10320,10352,10384,10416,10448,10480
.long 10496,10528,10560,10592,10624,10656,10688,10720
.long 10800,10768,10864,10832,10928,10896,10992,10960
.long 11040,11008,11104,11072,11168,11136,11232,11200
.long 11344,11376,11280,11312,11472,11504,11408,11440
.long 11584,11616,11520,11552,11712,11744,11648,11680
.long 11888,11856,11824,11792,12016,11984,11952,11920
.long 12128,12096,12064,12032,12256,12224,12192,12160
.long 16384,81920,8192,131072,16392,81928,8200,131080
.long 16400,81936,8208,131088,16408,81944,8216,131096
.long 16512,82048,8224,131200,16520,82056,8232,131208
.long 16528,82064,8240,131216,16536,82072,8248,131224
.long 16704,82240,8256,131392,16712,82248,8264,131400
.long 16720,82256,8272,131408,16728,82264,8280,131416
.long 16832,82368,8288,131520,16840,82376,8296,131528
.long 16848,82384,8304,131536,16856,82392,8312,131544
.long 16416,81952,8192,131104,16424,81960,8200,131112
.long 16432,81968,8208,131120,16440,81976,8216,131128
.long 16544,82080,8224,131232,16552,82088,8232,131240
.long 16560,82096,8240,131248,16568,82104,8248,131256
.long 16736,82272,8256,131424,16744,82280,8264,131432
.long 16752,82288,8272,131440,16760,82296,8280,131448
.long 16864,82400,8288,131552,16872,82408,8296,131560
.long 16880,82416,8304,131568,16888,82424,8312,131576
.long 18432,83968,8320,132096,18440,83976,8328,132104
.long 18448,83984,8336,132112,18456,83992,8344,132120
.long 18560,84096,8352,132224,18568,84104,8360,132232
.long 18576,84112,8368,132240,18584,84120,8376,132248
.long 18752,84288,8384,132416,18760,84296,8392,132424
.long 18768,84304,8400,132432,18776,84312,8408,132440
.long 18880,84416,8416,132544,18888,84424,8424,132552
.long 18896,84432,8432,132560,18904,84440,8440,132568
.long 18464,84000,8320,132128,18472,84008,8328,132136
.long 18480,84016,8336,132144,18488,84024,8344,132152
.long 18592,84128,8352,132256,18600,84136,8360,132264
.long 18608,84144,8368,132272,18616,84152,8376,132280
.long 18784,84320,8384,132448,18792,84328,8392,132456
.long 18800,84336,8400,132464,18808,84344,8408,132472
.long 18912,84448,8416,132576,18920,84456,8424,132584
.long 18928,84464,8432,132592,18936,84472,8440,132600
.long 0,0,40960,12288,16,16,40976,12304
.long 32,32,40992,12320,48,48,41008,12336
.long 128,64,41024,12352,144,80,41040,12368
.long 160,96,41056,12384,176,112,41072,12400
.long 64,128,41088,12416,80,144,41104,12432
.long 96,160,41120,12448,112,176,41136,12464
.long 192,192,41152,12480,208,208,41168,12496
.long 224,224,41184,12512,240,240,41200,12528
.long 256,65536,41216,12544,272,65552,41232,12560
.long 288,65568,41248,12576,304,65584,41264,12592
.long 384,65600,41280,12608,400,65616,41296,12624
.long 416,65632,41312,12640,432,65648,41328,12656
.long 320,65664,41344,12672,336,65680,41360,12688
.long 352,65696,41376,12704,368,65712,41392,12720
.long 448,65728,41408,12736,464,65744,41424,12752
.long 480,65760,41440,12768,496,65776,41456,12784
.long 512,256,41472,12800,528,272,41488,12816
.long 544,288,41504,12832,560,304,41520,12848
.long 640,320,41536,12864,656,336,41552,12880
.long 672,352,41568,12896,688,368,41584,12912
.long 576,384,41600,12928,592,400,41616,12944
.long 608,416,41632,12960,624,432,41648,12976
.long 704,448,41664,12992,720,464,41680,13008
.long 736,480,41696,13024,752,496,41712,13040
.long 768,65792,41728,13056,784,65808,41744,13072
.long 800,65824,41760,13088,816,65840,41776,13104
.long 896,65856,41792,13120,912,65872,41808,13136
.long 928,65888,41824,13152,944,65904,41840,13168
.long 832,65920,41856,13184,848,65936,41872,13200
.long 864,65952,41888,13216,880,65968,41904,13232
.long 960,65984,41920,13248,976,66000,41936,13264
.long 992,66016,41952,13280,1008,66032,41968,13296
.long 2048,2080,0,0,2048,2080,0,0
.long 2048,2080,0,0,2048,2080,0,0
.long 2048,2080,0,0,2048,2080,0,0
.long 2048,2080,0,0,2048,2080,0,0
.long 2048,2080,0,0,2048,2080,0,0
.long 2048,2080,0,0,2048,2080,0,0
.long 2048,2080,0,0,2048,2080,0,0
.long 2048,2080,0,0,2048,2080,0,0
.long 0,512,1065369472,1065369472,16,528,0,0
.long 32,544,0,0,48,560,0,0
.long 64,576,1065369472,1065369472,80,592,0,0
.long 96,608,0,0,112,624,0,0
.long 128,640,0,0,144,656,0,0
.long 160,672,0,0,176,688,0,0
.long 192,704,0,0,208,720,0,0
.long 224,736,0,0,240,752,0,0
.long 2064,2096,0,0,2064,2096,0,0
.long 2064,2096,0,0,2064,2096,0,0
.long 2064,2096,0,0,2064,2096,0,0
.long 2064,2096,0,0,2064,2096,0,0
.long 2064,2096,0,0,2064,2096,0,0
.long 2064,2096,0,0,2064,2096,0,0
.long 2064,2096,0,0,2064,2096,0,0
.long 2064,2096,0,0,2064,2096,0,0
.long 256,768,1065369472,1065369472,272,784,0,0
.long 288,800,0,0,304,816,0,0
.long 320,832,1065369472,1065369472,336,848,0,0
.long 352,864,0,0,368,880,0,0
.long 384,896,0,0,400,912,0,0
.long 416,928,0,0,432,944,0,0
.long 448,960,0,0,464,976,0,0
.long 480,992,0,0,496,1008,0,0
.long 16256,0,0,0,1065353216,0,0,0
.long 0,16256,0,0,0,1065353216,0,0
.long 0,0,0,0,0,0,0,0
.long 0,0,0,0,0,0,0,0
.long 0,0,16256,0,0,0,1065353216,0
.long 0,0,0,16256,0,0,0,1065353216
.long 0,0,0,0,0,0,0,0
.long 0,0,0,0,0,0,0,0
.long 0,0,0,0,0,0,0,0
.long 0,0,0,0,0,0,0,0
.long 0,0,0,0,0,0,0,0
.long 0,0,0,0,0,0,0,0
.long 0,0,0,0,0,0,0,0
.long 0,0,0,0,0,0,0,0
.long 0,0,0,0,0,0,0,0
.long 0,0,0,0,0,0,0,0
.long 0,0,0,0,0,0,0,0
.long 0,0,0,0,0,0,0,0
.long 16256,0,0,0,1065353216,0,0,0
.long 0,16256,0,0,0,1065353216,0,0
.long 0,0,0,0,0,0,0,0
.long 0,0,0,0,0,0,0,0
.long 0,0,16256,0,0,0,1065353216,0
.long 0,0,0,16256,0,0,0,1065353216
.long 0,0,0,0,0,0,0,0
.long 0,0,0,0,0,0,0,0
.long 0,0,0,0,0,0,0,0
.long 0,0,0,0,0,0,0,0
.long 0,0,0,0,0,0,0,0
.long 0,0,0,0,0,0,0,0
.long 0,0,0,0,0,0,0,0
.long 0,0,0,0,0,0,0,0
.long 0,0,0,0,0,0,0,0
.long 0,0,0,0,0,0,0,0
.long 0,0,0,0,0,0,0,0
.long 0,0,0,0,0,0,0,0
.long 0,0,0,0,0,0,0,0
.long 0,0,0,0,0,0,0,0
.long 0,0,0,0,0,0,0,0
.long 0,0,0,0,0,0,0,0
.long 16256,0,0,0,1065353216,0,0,0
.long 0,16256,0,0,0,1065353216,0,0
.long 0,0,0,0,0,0,0,0
.long 0,0,0,0,0,0,0,0
.long 0,0,16256,0,0,0,1065353216,0
.long 0,0,0,16256,0,0,0,1065353216
.long 0,0,0,0,0,0,0,0
.long 0,0,0,0,0,0,0,0
.long 0,0,0,0,0,0,0,0
.long 0,0,0,0,0,0,0,0
.long 0,0,0,0,0,0,0,0
.long 0,0,0,0,0,0,0,0
.long 0,0,0,0,0,0,0,0
.long 0,0,0,0,0,0,0,0
.long 0,0,0,0,0,0,0,0
.long 0,0,0,0,0,0,0,0
.long 0,0,0,0,0,0,0,0
.long 0,0,0,0,0,0,0,0
.long 16256,0,0,0,1065353216,0,0,0
.long 0,16256,0,0,0,1065353216,0,0
.long 0,0,0,0,0,0,0,0
.long 0,0,0,0,0,0,0,0
.long 0,0,16256,0,0,0,1065353216,0
.long 0,0,0,16256,0,0,0,1065353216
.long 0,137216,149504,32800,16,137232,149520,32808
.long 32,137248,149536,32816,48,137264,149552,32824
.long 64,137280,149568,32928,80,137296,149584,32936
.long 96,137312,149600,32944,112,137328,149616,32952
.long 1024,137344,149632,33120,1040,137360,149648,33128
.long 1056,137376,149664,33136,1072,137392,149680,33144
.long 1088,137408,149696,33248,1104,137424,149712,33256
.long 1120,137440,149728,33264,1136,137456,149744,33272
.long 2112,137472,149760,32768,2128,137488,149776,32776
.long 2144,137504,149792,32784,2160,137520,149808,32792
.long 2048,137536,149824,32896,2064,137552,149840,32904
.long 2080,137568,149856,32912,2096,137584,149872,32920
.long 3136,137600,149888,33088,3152,137616,149904,33096
.long 3168,137632,149920,33104,3184,137648,149936,33112
.long 3072,137664,149952,33216,3088,137680,149968,33224
.long 3104,137696,149984,33232,3120,137712,150000,33240
.long 4096,137728,150016,33312,4112,137744,150032,33320
.long 4128,137760,150048,33328,4144,137776,150064,33336
.long 4160,137792,150080,33440,4176,137808,150096,33448
.long 4192,137824,150112,33456,4208,137840,150128,33464
.long 5120,137856,150144,33632,5136,137872,150160,33640
.long 5152,137888,150176,33648,5168,137904,150192,33656
.long 5184,137920,150208,33760,5200,137936,150224,33768
.long 5216,137952,150240,33776,5232,137968,150256,33784
.long 6208,137984,150272,33280,6224,138000,150288,33288
.long 6240,138016,150304,33296,6256,138032,150320,33304
.long 6144,138048,150336,33408,6160,138064,150352,33416
.long 6176,138080,150368,33424,6192,138096,150384,33432
.long 7232,138112,150400,33600,7248,138128,150416,33608
.long 7264,138144,150432,33616,7280,138160,150448,33624
.long 7168,138176,150464,33728,7184,138192,150480,33736
.long 7200,138208,150496,33744,7216,138224,150512,33752
.long 32864,32768,0,0,32872,32784,1024,4
.long 32880,32800,2048,8,32888,32816,3072,12
.long 32992,32832,4096,16,33000,32848,5120,20
.long 33008,32864,6144,24,33016,32880,7168,28
.long 33056,32896,8192,32,33064,32912,9216,36
.long 33072,32928,10240,40,33080,32944,11264,44
.long 33184,32960,12288,48,33192,32976,13312,52
.long 33200,32992,14336,56,33208,33008,15360,60
.long 32832,33024,16384,64,32840,33040,17408,68
.long 32848,33056,18432,72,32856,33072,19456,76
.long 32960,33088,20480,80,32968,33104,21504,84
.long 32976,33120,22528,88,32984,33136,23552,92
.long 33024,33152,24576,96,33032,33168,25600,100
.long 33040,33184,26624,104,33048,33200,27648,108
.long 33152,33216,28672,112,33160,33232,29696,116
.long 33168,33248,30720,120,33176,33264,31744,124
.long 33376,33280,16,0,33384,33296,1040,4
.long 33392,33312,2064,8,33400,33328,3088,12
.long 33504,33344,4112,16,33512,33360,5136,20
.long 33520,33376,6160,24,33528,33392,7184,28
.long 33568,33408,8208,32,33576,33424,9232,36
.long 33584,33440,10256,40,33592,33456,11280,44
.long 33696,33472,12304,48,33704,33488,13328,52
.long 33712,33504,14352,56,33720,33520,15376,60
.long 33344,33536,16400,64,33352,33552,17424,68
.long 33360,33568,18448,72,33368,33584,19472,76
.long 33472,33600,20496,80,33480,33616,21520,84
.long 33488,33632,22544,88,33496,33648,23568,92
.long 33536,33664,24592,96,33544,33680,25616,100
.long 33552,33696,26640,104,33560,33712,27664,108
.long 33664,33728,28688,112,33672,33744,29712,116
.long 33680,33760,30736,120,33688,33776,31760,124
.long 12288,12320,12352,12384,12416,12448,12480,12512
.long 12560,12592,12624,12656,12688,12720,12752,12784
.long 12832,12800,12896,12864,12960,12928,13024,12992
.long 13104,13072,13168,13136,13232,13200,13296,13264
.long 13376,13408,13312,13344,13504,13536,13440,13472
.long 13648,13680,13584,13616,13776,13808,13712,13744
.long 13920,13888,13856,13824,14048,14016,13984,13952
.long 14192,14160,14128,14096,14320,14288,14256,14224
.long 14336,14368,14400,14432,14464,14496,14528,14560
.long 14608,14640,14672,14704,14736,14768,14800,14832
.long 14880,14848,14944,14912,15008,14976,15072,15040
.long 15152,15120,15216,15184,15280,15248,15344,15312
.long 15424,15456,15360,15392,15552,15584,15488,15520
.long 15696,15728,15632,15664,15824,15856,15760,15792
.long 15968,15936,15904,15872,16096,16064,16032,16000
.long 16240,16208,16176,16144,16368,16336,16304,16272
.long 12304,12336,12368,12400,12432,12464,12496,12528
.long 12544,12576,12608,12640,12672,12704,12736,12768
.long 12848,12816,12912,12880,12976,12944,13040,13008
.long 13088,13056,13152,13120,13216,13184,13280,13248
.long 13392,13424,13328,13360,13520,13552,13456,13488
.long 13632,13664,13568,13600,13760,13792,13696,13728
.long 13936,13904,13872,13840,14064,14032,14000,13968
.long 14176,14144,14112,14080,14304,14272,14240,14208
.long 14352,14384,14416,14448,14480,14512,14544,14576
.long 14592,14624,14656,14688,14720,14752,14784,14816
.long 14896,14864,14960,14928,15024,14992,15088,15056
.long 15136,15104,15200,15168,15264,15232,15328,15296
.long 15440,15472,15376,15408,15568,15600,15504,15536
.long 15680,15712,15616,15648,15808,15840,15744,15776
.long 15984,15952,15920,15888,16112,16080,16048,16016
.long 16224,16192,16160,16128,16352,16320,16288,16256
.long 16384,81920,8192,131072,16392,81928,8200,131080
.long 16400,81936,8208,131088,16408,81944,8216,131096
.long 16512,82048,8224,131200,16520,82056,8232,131208
.long 16528,82064,8240,131216,16536,82072,8248,131224
.long 16704,82240,8256,131392,16712,82248,8264,131400
.long 16720,82256,8272,131408,16728,82264,8280,131416
.long 16832,82368,8288,131520,16840,82376,8296,131528
.long 16848,82384,8304,131536,16856,82392,8312,131544
.long 16416,81952,8192,131104,16424,81960,8200,131112
.long 16432,81968,8208,131120,16440,81976,8216,131128
.long 16544,82080,8224,131232,16552,82088,8232,131240
.long 16560,82096,8240,131248,16568,82104,8248,131256
.long 16736,82272,8256,131424,16744,82280,8264,131432
.long 16752,82288,8272,131440,16760,82296,8280,131448
.long 16864,82400,8288,131552,16872,82408,8296,131560
.long 16880,82416,8304,131568,16888,82424,8312,131576
.long 18432,83968,8320,132096,18440,83976,8328,132104
.long 18448,83984,8336,132112,18456,83992,8344,132120
.long 18560,84096,8352,132224,18568,84104,8360,132232
.long 18576,84112,8368,132240,18584,84120,8376,132248
.long 18752,84288,8384,132416,18760,84296,8392,132424
.long 18768,84304,8400,132432,18776,84312,8408,132440
.long 18880,84416,8416,132544,18888,84424,8424,132552
.long 18896,84432,8432,132560,18904,84440,8440,132568
.long 18464,84000,8320,132128,18472,84008,8328,132136
.long 18480,84016,8336,132144,18488,84024,8344,132152
.long 18592,84128,8352,132256,18600,84136,8360,132264
.long 18608,84144,8368,132272,18616,84152,8376,132280
.long 18784,84320,8384,132448,18792,84328,8392,132456
.long 18800,84336,8400,132464,18808,84344,8408,132472
.long 18912,84448,8416,132576,18920,84456,8424,132584
.long 18928,84464,8432,132592,18936,84472,8440,132600
.long 0,0,49152,14336,16,16,49168,14352
.long 32,32,49184,14368,48,48,49200,14384
.long 128,64,49216,14400,144,80,49232,14416
.long 160,96,49248,14432,176,112,49264,14448
.long 64,128,49280,14464,80,144,49296,14480
.long 96,160,49312,14496,112,176,49328,14512
.long 192,192,49344,14528,208,208,49360,14544
.long 224,224,49376,14560,240,240,49392,14576
.long 256,65536,49408,14592,272,65552,49424,14608
.long 288,65568,49440,14624,304,65584,49456,14640
.long 384,65600,49472,14656,400,65616,49488,14672
.long 416,65632,49504,14688,432,65648,49520,14704
.long 320,65664,49536,14720,336,65680,49552,14736
.long 352,65696,49568,14752,368,65712,49584,14768
.long 448,65728,49600,14784,464,65744,49616,14800
.long 480,65760,49632,14816,496,65776,49648,14832
.long 512,256,49664,14848,528,272,49680,14864
.long 544,288,49696,14880,560,304,49712,14896
.long 640,320,49728,14912,656,336,49744,14928
.long 672,352,49760,14944,688,368,49776,14960
.long 576,384,49792,14976,592,400,49808,14992
.long 608,416,49824,15008,624,432,49840,15024
.long 704,448,49856,15040,720,464,49872,15056
.long 736,480,49888,15072,752,496,49904,15088
.long 768,65792,49920,15104,784,65808,49936,15120
.long 800,65824,49952,15136,816,65840,49968,15152
.long 896,65856,49984,15168,912,65872,50000,15184
.long 928,65888,50016,15200,944,65904,50032,15216
.long 832,65920,50048,15232,848,65936,50064,15248
.long 864,65952,50080,15264,880,65968,50096,15280
.long 960,65984,50112,15296,976,66000,50128,15312
.long 992,66016,50144,15328,1008,66032,50160,15344
.long 2112,2144,0,0,2112,2144,0,0
.long 2112,2144,0,0,2112,2144,0,0
.long 2112,2144,0,0,2112,2144,0,0
.long 2112,2144,0,0,2112,2144,0,0
.long 2112,2144,0,0,2112,2144,0,0
.long 2112,2144,0,0,2112,2144,0,0
.long 2112,2144,0,0,2112,2144,0,0
.long 2112,2144,0,0,2112,2144,0,0
.long 1024,1536,1065369472,1065369472,1040,1552,0,0
.long 1056,1568,0,0,1072,1584,0,0
.long 1088,1600,1065369472,1065369472,1104,1616,0,0
.long 1120,1632,0,0,1136,1648,0,0
.long 1152,1664,0,0,1168,1680,0,0
.long 1184,1696,0,0,1200,1712,0,0
.long 1216,1728,0,0,1232,1744,0,0
.long 1248,1760,0,0,1264,1776,0,0
.long 2128,2160,0,0,2128,2160,0,0
.long 2128,2160,0,0,2128,2160,0,0
.long 2128,2160,0,0,2128,2160,0,0
.long 2128,2160,0,0,2128,2160,0,0
.long 2128,2160,0,0,2128,2160,0,0
.long 2128,2160,0,0,2128,2160,0,0
.long 2128,2160,0,0,2128,2160,0,0
.long 2128,2160,0,0,2128,2160,0,0
.long 1280,1792,1065369472,1065369472,1296,1808,0,0
.long 1312,1824,0,0,1328,1840,0,0
.long 1344,1856,1065369472,1065369472,1360,1872,0,0
.long 1376,1888,0,0,1392,1904,0,0
.long 1408,1920,0,0,1424,1936,0,0
.long 1440,1952,0,0,1456,1968,0,0
.long 1472,1984,0,0,1488,2000,0,0
.long 1504,2016,0,0,1520,2032,0,0
.long 16256,0,0,0,1065353216,0,0,0
.long 0,16256,0,0,0,1065353216,0,0
.long 0,0,0,0,0,0,0,0
.long 0,0,0,0,0,0,0,0
.long 0,0,16256,0,0,0,1065353216,0
.long 0,0,0,16256,0,0,0,1065353216
.long 0,0,0,0,0,0,0,0
.long 0,0,0,0,0,0,0,0
.long 0,0,0,0,0,0,0,0
.long 0,0,0,0,0,0,0,0
.long 0,0,0,0,0,0,0,0
.long 0,0,0,0,0,0,0,0
.long 0,0,0,0,0,0,0,0
.long 0,0,0,0,0,0,0,0
.long 0,0,0,0,0,0,0,0
.long 0,0,0,0,0,0,0,0
.long 0,0,0,0,0,0,0,0
.long 0,0,0,0,0,0,0,0
.long 16256,0,0,0,1065353216,0,0,0
.long 0,16256,0,0,0,1065353216,0,0
.long 0,0,0,0,0,0,0,0
.long 0,0,0,0,0,0,0,0
.long 0,0,16256,0,0,0,1065353216,0
.long 0,0,0,16256,0,0,0,1065353216
.long 0,0,0,0,0,0,0,0
.long 0,0,0,0,0,0,0,0
.long 0,0,0,0,0,0,0,0
.long 0,0,0,0,0,0,0,0
.long 0,0,0,0,0,0,0,0
.long 0,0,0,0,0,0,0,0
.long 0,0,0,0,0,0,0,0
.long 0,0,0,0,0,0,0,0
.long 0,0,0,0,0,0,0,0
.long 0,0,0,0,0,0,0,0
.long 0,0,0,0,0,0,0,0
.long 0,0,0,0,0,0,0,0
.long 0,0,0,0,0,0,0,0
.long 0,0,0,0,0,0,0,0
.long 0,0,0,0,0,0,0,0
.long 0,0,0,0,0,0,0,0
.long 16256,0,0,0,1065353216,0,0,0
.long 0,16256,0,0,0,1065353216,0,0
.long 0,0,0,0,0,0,0,0
.long 0,0,0,0,0,0,0,0
.long 0,0,16256,0,0,0,1065353216,0
.long 0,0,0,16256,0,0,0,1065353216
.long 0,0,0,0,0,0,0,0
.long 0,0,0,0,0,0,0,0
.long 0,0,0,0,0,0,0,0
.long 0,0,0,0,0,0,0,0
.long 0,0,0,0,0,0,0,0
.long 0,0,0,0,0,0,0,0
.long 0,0,0,0,0,0,0,0
.long 0,0,0,0,0,0,0,0
.long 0,0,0,0,0,0,0,0
.long 0,0,0,0,0,0,0,0
.long 0,0,0,0,0,0,0,0
.long 0,0,0,0,0,0,0,0
.long 16256,0,0,0,1065353216,0,0,0
.long 0,16256,0,0,0,1065353216,0,0
.long 0,0,0,0,0,0,0,0
.long 0,0,0,0,0,0,0,0
.long 0,0,16256,0,0,0,1065353216,0
.long 0,0,0,16256,0,0,0,1065353216
.long 0,140288,152576,32800,16,140304,152592,32808
.long 32,140320,152608,32816,48,140336,152624,32824
.long 64,140352,152640,32928,80,140368,152656,32936
.long 96,140384,152672,32944,112,140400,152688,32952
.long 1024,140416,152704,33120,1040,140432,152720,33128
.long 1056,140448,152736,33136,1072,140464,152752,33144
.long 1088,140480,152768,33248,1104,140496,152784,33256
.long 1120,140512,152800,33264,1136,140528,152816,33272
.long 2112,140544,152832,32768,2128,140560,152848,32776
.long 2144,140576,152864,32784,2160,140592,152880,32792
.long 2048,140608,152896,32896,2064,140624,152912,32904
.long 2080,140640,152928,32912,2096,140656,152944,32920
.long 3136,140672,152960,33088,3152,140688,152976,33096
.long 3168,140704,152992,33104,3184,140720,153008,33112
.long 3072,140736,153024,33216,3088,140752,153040,33224
.long 3104,140768,153056,33232,3120,140784,153072,33240
.long 4096,140800,153088,33312,4112,140816,153104,33320
.long 4128,140832,153120,33328,4144,140848,153136,33336
.long 4160,140864,153152,33440,4176,140880,153168,33448
.long 4192,140896,153184,33456,4208,140912,153200,33464
.long 5120,140928,153216,33632,5136,140944,153232,33640
.long 5152,140960,153248,33648,5168,140976,153264,33656
.long 5184,140992,153280,33760,5200,141008,153296,33768
.long 5216,141024,153312,33776,5232,141040,153328,33784
.long 6208,141056,153344,33280,6224,141072,153360,33288
.long 6240,141088,153376,33296,6256,141104,153392,33304
.long 6144,141120,153408,33408,6160,141136,153424,33416
.long 6176,141152,153440,33424,6192,141168,153456,33432
.long 7232,141184,153472,33600,7248,141200,153488,33608
.long 7264,141216,153504,33616,7280,141232,153520,33624
.long 7168,141248,153536,33728,7184,141264,153552,33736
.long 7200,141280,153568,33744,7216,141296,153584,33752
.long 32864,40960,0,0,32872,40976,1024,4
.long 32880,40992,2048,8,32888,41008,3072,12
.long 32992,41024,4096,16,33000,41040,5120,20
.long 33008,41056,6144,24,33016,41072,7168,28
.long 33056,41088,8192,32,33064,41104,9216,36
.long 33072,41120,10240,40,33080,41136,11264,44
.long 33184,41152,12288,48,33192,41168,13312,52
.long 33200,41184,14336,56,33208,41200,15360,60
.long 32832,41216,16384,64,32840,41232,17408,68
.long 32848,41248,18432,72,32856,41264,19456,76
.long 32960,41280,20480,80,32968,41296,21504,84
.long 32976,41312,22528,88,32984,41328,23552,92
.long 33024,41344,24576,96,33032,41360,25600,100
.long 33040,41376,26624,104,33048,41392,27648,108
.long 33152,41408,28672,112,33160,41424,29696,116
.long 33168,41440,30720,120,33176,41456,31744,124
.long 33376,41472,16,0,33384,41488,1040,4
.long 33392,41504,2064,8,33400,41520,3088,12
.long 33504,41536,4112,16,33512,41552,5136,20
.long 33520,41568,6160,24,33528,41584,7184,28
.long 33568,41600,8208,32,33576,41616,9232,36
.long 33584,41632,10256,40,33592,41648,11280,44
.long 33696,41664,12304,48,33704,41680,13328,52
.long 33712,41696,14352,56,33720,41712,15376,60
.long 33344,41728,16400,64,33352,41744,17424,68
.long 33360,41760,18448,72,33368,41776,19472,76
.long 33472,41792,20496,80,33480,41808,21520,84
.long 33488,41824,22544,88,33496,41840,23568,92
.long 33536,41856,24592,96,33544,41872,25616,100
.long 33552,41888,26640,104,33560,41904,27664,108
.long 33664,41920,28688,112,33672,41936,29712,116
.long 33680,41952,30736,120,33688,41968,31760,124
.long 0,32,64,96,128,160,192,224
.long 272,304,336,368,400,432,464,496
.long 544,512,608,576,672,640,736,704
.long 816,784,880,848,944,912,1008,976
.long 1088,1120,1024,1056,1216,1248,1152,1184
.long 1360,1392,1296,1328,1488,1520,1424,1456
.long 1632,1600,1568,1536,1760,1728,1696,1664
.long 1904,1872,1840,1808,2032,2000,1968,1936
.long 2048,2080,2112,2144,2176,2208,2240,2272
.long 2320,2352,2384,2416,2448,2480,2512,2544
.long 2592,2560,2656,2624,2720,2688,2784,2752
.long 2864,2832,2928,2896,2992,2960,3056,3024
.long 3136,3168,3072,3104,3264,3296,3200,3232
.long 3408,3440,3344,3376,3536,3568,3472,3504
.long 3680,3648,3616,3584,3808,3776,3744,3712
.long 3952,3920,3888,3856,4080,4048,4016,3984
.long 16,48,80,112,144,176,208,240
.long 256,288,320,352,384,416,448,480
.long 560,528,624,592,688,656,752,720
.long 800,768,864,832,928,896,992,960
.long 1104,1136,1040,1072,1232,1264,1168,1200
.long 1344,1376,1280,1312,1472,1504,1408,1440
.long 1648,1616,1584,1552,1776,1744,1712,1680
.long 1888,1856,1824,1792,2016,1984,1952,1920
.long 2064,2096,2128,2160,2192,2224,2256,2288
.long 2304,2336,2368,2400,2432,2464,2496,2528
.long 2608,2576,2672,2640,2736,2704,2800,2768
.long 2848,2816,2912,2880,2976,2944,3040,3008
.long 3152,3184,3088,3120,3280,3312,3216,3248
.long 3392,3424,3328,3360,3520,3552,3456,3488
.long 3696,3664,3632,3600,3824,3792,3760,3728
.long 3936,3904,3872,3840,4064,4032,4000,3968
.long 16448,81984,9216,131136,16456,81992,9224,131144
.long 16464,82000,9232,131152,16472,82008,9240,131160
.long 16576,82112,9248,131264,16584,82120,9256,131272
.long 16592,82128,9264,131280,16600,82136,9272,131288
.long 16640,82176,9280,131328,16648,82184,9288,131336
.long 16656,82192,9296,131344,16664,82200,9304,131352
.long 16768,82304,9312,131456,16776,82312,9320,131464
.long 16784,82320,9328,131472,16792,82328,9336,131480
.long 16480,82016,9216,131168,16488,82024,9224,131176
.long 16496,82032,9232,131184,16504,82040,9240,131192
.long 16608,82144,9248,131296,16616,82152,9256,131304
.long 16624,82160,9264,131312,16632,82168,9272,131320
.long 16672,82208,9280,131360,16680,82216,9288,131368
.long 16688,82224,9296,131376,16696,82232,9304,131384
.long 16800,82336,9312,131488,16808,82344,9320,131496
.long 16816,82352,9328,131504,16824,82360,9336,131512
.long 18496,84032,9344,132160,18504,84040,9352,132168
.long 18512,84048,9360,132176,18520,84056,9368,132184
.long 18624,84160,9376,132288,18632,84168,9384,132296
.long 18640,84176,9392,132304,18648,84184,9400,132312
.long 18688,84224,9408,132352,18696,84232,9416,132360
.long 18704,84240,9424,132368,18712,84248,9432,132376
.long 18816,84352,9440,132480,18824,84360,9448,132488
.long 18832,84368,9456,132496,18840,84376,9464,132504
.long 18528,84064,9344,132192,18536,84072,9352,132200
.long 18544,84080,9360,132208,18552,84088,9368,132216
.long 18656,84192,9376,132320,18664,84200,9384,132328
.long 18672,84208,9392,132336,18680,84216,9400,132344
.long 18720,84256,9408,132384,18728,84264,9416,132392
.long 18736,84272,9424,132400,18744,84280,9432,132408
.long 18848,84384,9440,132512,18856,84392,9448,132520
.long 18864,84400,9456,132528,18872,84408,9464,132536
.long 0,0,73728,73728,16,16,73744,73744
.long 32,32,73760,73760,48,48,73776,73776
.long 128,64,73792,73792,144,80,73808,73808
.long 160,96,73824,73824,176,112,73840,73840
.long 64,128,73856,73856,80,144,73872,73872
.long 96,160,73888,73888,112,176,73904,73904
.long 192,192,73920,73920,208,208,73936,73936
.long 224,224,73952,73952,240,240,73968,73968
.long 256,65536,73984,73984,272,65552,74000,74000
.long 288,65568,74016,74016,304,65584,74032,74032
.long 384,65600,74048,74048,400,65616,74064,74064
.long 416,65632,74080,74080,432,65648,74096,74096
.long 320,65664,74112,74112,336,65680,74128,74128
.long 352,65696,74144,74144,368,65712,74160,74160
.long 448,65728,74176,74176,464,65744,74192,74192
.long 480,65760,74208,74208,496,65776,74224,74224
.long 512,256,74240,74240,528,272,74256,74256
.long 544,288,74272,74272,560,304,74288,74288
.long 640,320,74304,74304,656,336,74320,74320
.long 672,352,74336,74336,688,368,74352,74352
.long 576,384,74368,74368,592,400,74384,74384
.long 608,416,74400,74400,624,432,74416,74416
.long 704,448,74432,74432,720,464,74448,74448
.long 736,480,74464,74464,752,496,74480,74480
.long 768,65792,74496,74496,784,65808,74512,74512
.long 800,65824,74528,74528,816,65840,74544,74544
.long 896,65856,74560,74560,912,65872,74576,74576
.long 928,65888,74592,74592,944,65904,74608,74608
.long 832,65920,74624,74624,848,65936,74640,74640
.long 864,65952,74656,74656,880,65968,74672,74672
.long 960,65984,74688,74688,976,66000,74704,74704
.long 992,66016,74720,74720,1008,66032,74736,74736
.long 0,512,0,0,16,528,0,0
.long 32,544,0,0,48,560,0,0
.long 64,576,0,0,80,592,0,0
.long 96,608,0,0,112,624,0,0
.long 128,640,0,0,144,656,0,0
.long 160,672,0,0,176,688,0,0
.long 192,704,0,0,208,720,0,0
.long 224,736,0,0,240,752,0,0
.long 2048,2080,1065369472,1065369472,2048,2080,0,0
.long 2048,2080,0,0,2048,2080,0,0
.long 2048,2080,1065369472,1065369472,2048,2080,0,0
.long 2048,2080,0,0,2048,2080,0,0
.long 2048,2080,0,0,2048,2080,0,0
.long 2048,2080,0,0,2048,2080,0,0
.long 2048,2080,0,0,2048,2080,0,0
.long 2048,2080,0,0,2048,2080,0,0
.long 256,768,0,0,272,784,0,0
.long 288,800,0,0,304,816,0,0
.long 320,832,0,0,336,848,0,0
.long 352,864,0,0,368,880,0,0
.long 384,896,0,0,400,912,0,0
.long 416,928,0,0,432,944,0,0
.long 448,960,0,0,464,976,0,0
.long 480,992,0,0,496,1008,0,0
.long 2064,2096,1065369472,1065369472,2064,2096,0,0
.long 2064,2096,0,0,2064,2096,0,0
.long 2064,2096,1065369472,1065369472,2064,2096,0,0
.long 2064,2096,0,0,2064,2096,0,0
.long 2064,2096,0,0,2064,2096,0,0
.long 2064,2096,0,0,2064,2096,0,0
.long 2064,2096,0,0,2064,2096,0,0
.long 2064,2096,0,0,2064,2096,0,0
.long 16256,0,0,0,1065353216,0,0,0
.long 0,16256,0,0,0,1065353216,0,0
.long 0,0,0,0,0,0,0,0
.long 0,0,0,0,0,0,0,0
.long 0,0,16256,0,0,0,1065353216,0
.long 0,0,0,16256,0,0,0,1065353216
.long 0,0,0,0,0,0,0,0
.long 0,0,0,0,0,0,0,0
.long 0,0,0,0,0,0,0,0
.long 0,0,0,0,0,0,0,0
.long 0,0,0,0,0,0,0,0
.long 0,0,0,0,0,0,0,0
.long 0,0,0,0,0,0,0,0
.long 0,0,0,0,0,0,0,0
.long 0,0,0,0,0,0,0,0
.long 0,0,0,0,0,0,0,0
.long 0,0,0,0,0,0,0,0
.long 0,0,0,0,0,0,0,0
.long 16256,0,0,0,1065353216,0,0,0
.long 0,16256,0,0,0,1065353216,0,0
.long 0,0,0,0,0,0,0,0
.long 0,0,0,0,0,0,0,0
.long 0,0,16256,0,0,0,1065353216,0
.long 0,0,0,16256,0,0,0,1065353216
.long 0,0,0,0,0,0,0,0
.long 0,0,0,0,0,0,0,0
.long 0,0,0,0,0,0,0,0
.long 0,0,0,0,0,0,0,0
.long 0,0,0,0,0,0,0,0
.long 0,0,0,0,0,0,0,0
.long 0,0,0,0,0,0,0,0
.long 0,0,0,0,0,0,0,0
.long 0,0,0,0,0,0,0,0
.long 0,0,0,0,0,0,0,0
.long 0,0,0,0,0,0,0,0
.long 0,0,0,0,0,0,0,0
.long 0,0,0,0,0,0,0,0
.long 0,0,0,0,0,0,0,0
.long 0,0,0,0,0,0,0,0
.long 0,0,0,0,0,0,0,0
.long 16256,0,0,0,1065353216,0,0,0
.long 0,16256,0,0,0,1065353216,0,0
.long 0,0,0,0,0,0,0,0
.long 0,0,0,0,0,0,0,0
.long 0,0,16256,0,0,0,1065353216,0
.long 0,0,0,16256,0,0,0,1065353216
.long 0,0,0,0,0,0,0,0
.long 0,0,0,0,0,0,0,0
.long 0,0,0,0,0,0,0,0
.long 0,0,0,0,0,0,0,0
.long 0,0,0,0,0,0,0,0
.long 0,0,0,0,0,0,0,0
.long 0,0,0,0,0,0,0,0
.long 0,0,0,0,0,0,0,0
.long 0,0,0,0,0,0,0,0
.long 0,0,0,0,0,0,0,0
.long 0,0,0,0,0,0,0,0
.long 0,0,0,0,0,0,0,0
.long 16256,0,0,0,1065353216,0,0,0
.long 0,16256,0,0,0,1065353216,0,0
.long 0,0,0,0,0,0,0,0
.long 0,0,0,0,0,0,0,0
.long 0,0,16256,0,0,0,1065353216,0
.long 0,0,0,16256,0,0,0,1065353216
.long 0,143360,131072,65600,16,143376,131088,65608
.long 32,143392,131104,65616,48,143408,131120,65624
.long 64,143424,131136,65728,80,143440,131152,65736
.long 96,143456,131168,65744,112,143472,131184,65752
.long 1024,143488,131200,65792,1040,143504,131216,65800
.long 1056,143520,131232,65808,1072,143536,131248,65816
.long 1088,143552,131264,65920,1104,143568,131280,65928
.long 1120,143584,131296,65936,1136,143600,131312,65944
.long 2112,143616,131328,65632,2128,143632,131344,65640
.long 2144,143648,131360,65648,2160,143664,131376,65656
.long 2048,143680,131392,65760,2064,143696,131408,65768
.long 2080,143712,131424,65776,2096,143728,131440,65784
.long 3136,143744,131456,65824,3152,143760,131472,65832
.long 3168,143776,131488,65840,3184,143792,131504,65848
.long 3072,143808,131520,65952,3088,143824,131536,65960
.long 3104,143840,131552,65968,3120,143856,131568,65976
.long 4096,143872,131584,66112,4112,143888,131600,66120
.long 4128,143904,131616,66128,4144,143920,131632,66136
.long 4160,143936,131648,66240,4176,143952,131664,66248
.long 4192,143968,131680,66256,4208,143984,131696,66264
.long 5120,144000,131712,66304,5136,144016,131728,66312
.long 5152,144032,131744,66320,5168,144048,131760,66328
.long 5184,144064,131776,66432,5200,144080,131792,66440
.long 5216,144096,131808,66448,5232,144112,131824,66456
.long 6208,144128,131840,66144,6224,144144,131856,66152
.long 6240,144160,131872,66160,6256,144176,131888,66168
.long 6144,144192,131904,66272,6160,144208,131920,66280
.long 6176,144224,131936,66288,6192,144240,131952,66296
.long 7232,144256,131968,66336,7248,144272,131984,66344
.long 7264,144288,132000,66352,7280,144304,132016,66360
.long 7168,144320,132032,66464,7184,144336,132048,66472
.long 7200,144352,132064,66480,7216,144368,132080,66488
.long 65536,65536,0,0,65544,65552,1024,4
.long 65552,65568,2048,8,65560,65584,3072,12
.long 65664,65600,4096,16,65672,65616,5120,20
.long 65680,65632,6144,24,65688,65648,7168,28
.long 65856,65664,8192,32,65864,65680,9216,36
.long 65872,65696,10240,40,65880,65712,11264,44
.long 65984,65728,12288,48,65992,65744,13312,52
.long 66000,65760,14336,56,66008,65776,15360,60
.long 65568,65792,16384,64,65576,65808,17408,68
.long 65584,65824,18432,72,65592,65840,19456,76
.long 65696,65856,20480,80,65704,65872,21504,84
.long 65712,65888,22528,88,65720,65904,23552,92
.long 65888,65920,24576,96,65896,65936,25600,100
.long 65904,65952,26624,104,65912,65968,27648,108
.long 66016,65984,28672,112,66024,66000,29696,116
.long 66032,66016,30720,120,66040,66032,31744,124
.long 66048,66048,16,0,66056,66064,1040,4
.long 66064,66080,2064,8,66072,66096,3088,12
.long 66176,66112,4112,16,66184,66128,5136,20
.long 66192,66144,6160,24,66200,66160,7184,28
.long 66368,66176,8208,32,66376,66192,9232,36
.long 66384,66208,10256,40,66392,66224,11280,44
.long 66496,66240,12304,48,66504,66256,13328,52
.long 66512,66272,14352,56,66520,66288,15376,60
.long 66080,66304,16400,64,66088,66320,17424,68
.long 66096,66336,18448,72,66104,66352,19472,76
.long 66208,66368,20496,80,66216,66384,21520,84
.long 66224,66400,22544,88,66232,66416,23568,92
.long 66400,66432,24592,96,66408,66448,25616,100
.long 66416,66464,26640,104,66424,66480,27664,108
.long 66528,66496,28688,112,66536,66512,29712,116
.long 66544,66528,30736,120,66552,66544,31760,124
.long 4096,4128,4160,4192,4224,4256,4288,4320
.long 4368,4400,4432,4464,4496,4528,4560,4592
.long 4640,4608,4704,4672,4768,4736,4832,4800
.long 4912,4880,4976,4944,5040,5008,5104,5072
.long 5184,5216,5120,5152,5312,5344,5248,5280
.long 5456,5488,5392,5424,5584,5616,5520,5552
.long 5728,5696,5664,5632,5856,5824,5792,5760
.long 6000,5968,5936,5904,6128,6096,6064,6032
.long 6144,6176,6208,6240,6272,6304,6336,6368
.long 6416,6448,6480,6512,6544,6576,6608,6640
.long 6688,6656,6752,6720,6816,6784,6880,6848
.long 6960,6928,7024,6992,7088,7056,7152,7120
.long 7232,7264,7168,7200,7360,7392,7296,7328
.long 7504,7536,7440,7472,7632,7664,7568,7600
.long 7776,7744,7712,7680,7904,7872,7840,7808
.long 8048,8016,7984,7952,8176,8144,8112,8080
.long 4112,4144,4176,4208,4240,4272,4304,4336
.long 4352,4384,4416,4448,4480,4512,4544,4576
.long 4656,4624,4720,4688,4784,4752,4848,4816
.long 4896,4864,4960,4928,5024,4992,5088,5056
.long 5200,5232,5136,5168,5328,5360,5264,5296
.long 5440,5472,5376,5408,5568,5600,5504,5536
.long 5744,5712,5680,5648,5872,5840,5808,5776
.long 5984,5952,5920,5888,6112,6080,6048,6016
.long 6160,6192,6224,6256,6288,6320,6352,6384
.long 6400,6432,6464,6496,6528,6560,6592,6624
.long 6704,6672,6768,6736,6832,6800,6896,6864
.long 6944,6912,7008,6976,7072,7040,7136,7104
.long 7248,7280,7184,7216,7376,7408,7312,7344
.long 7488,7520,7424,7456,7616,7648,7552,7584
.long 7792,7760,7728,7696,7920,7888,7856,7824
.long 8032,8000,7968,7936,8160,8128,8096,8064
.long 16448,81984,9216,131136,16456,81992,9224,131144
.long 16464,82000,9232,131152,16472,82008,9240,131160
.long 16576,82112,9248,131264,16584,82120,9256,131272
.long 16592,82128,9264,131280,16600,82136,9272,131288
.long 16640,82176,9280,131328,16648,82184,9288,131336
.long 16656,82192,9296,131344,16664,82200,9304,131352
.long 16768,82304,9312,131456,16776,82312,9320,131464
.long 16784,82320,9328,131472,16792,82328,9336,131480
.long 16480,82016,9216,131168,16488,82024,9224,131176
.long 16496,82032,9232,131184,16504,82040,9240,131192
.long 16608,82144,9248,131296,16616,82152,9256,131304
.long 16624,82160,9264,131312,16632,82168,9272,131320
.long 16672,82208,9280,131360,16680,82216,9288,131368
.long 16688,82224,9296,131376,16696,82232,9304,131384
.long 16800,82336,9312,131488,16808,82344,9320,131496
.long 16816,82352,9328,131504,16824,82360,9336,131512
.long 18496,84032,9344,132160,18504,84040,9352,132168
.long 18512,84048,9360,132176,18520,84056,9368,132184
.long 18624,84160,9376,132288,18632,84168,9384,132296
.long 18640,84176,9392,132304,18648,84184,9400,132312
.long 18688,84224,9408,132352,18696,84232,9416,132360
.long 18704,84240,9424,132368,18712,84248,9432,132376
.long 18816,84352,9440,132480,18824,84360,9448,132488
.long 18832,84368,9456,132496,18840,84376,9464,132504
.long 18528,84064,9344,132192,18536,84072,9352,132200
.long 18544,84080,9360,132208,18552,84088,9368,132216
.long 18656,84192,9376,132320,18664,84200,9384,132328
.long 18672,84208,9392,132336,18680,84216,9400,132344
.long 18720,84256,9408,132384,18728,84264,9416,132392
.long 18736,84272,9424,132400,18744,84280,9432,132408
.long 18848,84384,9440,132512,18856,84392,9448,132520
.long 18864,84400,9456,132528,18872,84408,9464,132536
.long 0,0,81920,75776,16,16,81936,75792
.long 32,32,81952,75808,48,48,81968,75824
.long 128,64,81984,75840,144,80,82000,75856
.long 160,96,82016,75872,176,112,82032,75888
.long 64,128,82048,75904,80,144,82064,75920
.long 96,160,82080,75936,112,176,82096,75952
.long 192,192,82112,75968,208,208,82128,75984
.long 224,224,82144,76000,240,240,82160,76016
.long 256,65536,82176,76032,272,65552,82192,76048
.long 288,65568,82208,76064,304,65584,82224,76080
.long 384,65600,82240,76096,400,65616,82256,76112
.long 416,65632,82272,76128,432,65648,82288,76144
.long 320,65664,82304,76160,336,65680,82320,76176
.long 352,65696,82336,76192,368,65712,82352,76208
.long 448,65728,82368,76224,464,65744,82384,76240
.long 480,65760,82400,76256,496,65776,82416,76272
.long 512,256,82432,76288,528,272,82448,76304
.long 544,288,82464,76320,560,304,82480,76336
.long 640,320,82496,76352,656,336,82512,76368
.long 672,352,82528,76384,688,368,82544,76400
.long 576,384,82560,76416,592,400,82576,76432
.long 608,416,82592,76448,624,432,82608,76464
.long 704,448,82624,76480,720,464,82640,76496
.long 736,480,82656,76512,752,496,82672,76528
.long 768,65792,82688,76544,784,65808,82704,76560
.long 800,65824,82720,76576,816,65840,82736,76592
.long 896,65856,82752,76608,912,65872,82768,76624
.long 928,65888,82784,76640,944,65904,82800,76656
.long 832,65920,82816,76672,848,65936,82832,76688
.long 864,65952,82848,76704,880,65968,82864,76720
.long 960,65984,82880,76736,976,66000,82896,76752
.long 992,66016,82912,76768,1008,66032,82928,76784
.long 1024,1536,0,0,1040,1552,0,0
.long 1056,1568,0,0,1072,1584,0,0
.long 1088,1600,0,0,1104,1616,0,0
.long 1120,1632,0,0,1136,1648,0,0
.long 1152,1664,0,0,1168,1680,0,0
.long 1184,1696,0,0,1200,1712,0,0
.long 1216,1728,0,0,1232,1744,0,0
.long 1248,1760,0,0,1264,1776,0,0
.long 2112,2144,1065369472,1065369472,2112,2144,0,0
.long 2112,2144,0,0,2112,2144,0,0
.long 2112,2144,1065369472,1065369472,2112,2144,0,0
.long 2112,2144,0,0,2112,2144,0,0
.long 2112,2144,0,0,2112,2144,0,0
.long 2112,2144,0,0,2112,2144,0,0
.long 2112,2144,0,0,2112,2144,0,0
.long 2112,2144,0,0,2112,2144,0,0
.long 1280,1792,0,0,1296,1808,0,0
.long 1312,1824,0,0,1328,1840,0,0
.long 1344,1856,0,0,1360,1872,0,0
.long 1376,1888,0,0,1392,1904,0,0
.long 1408,1920,0,0,1424,1936,0,0
.long 1440,1952,0,0,1456,1968,0,0
.long 1472,1984,0,0,1488,2000,0,0
.long 1504,2016,0,0,1520,2032,0,0
.long 2128,2160,1065369472,1065369472,2128,2160,0,0
.long 2128,2160,0,0,2128,2160,0,0
.long 2128,2160,1065369472,1065369472,2128,2160,0,0
.long 2128,2160,0,0,2128,2160,0,0
.long 2128,2160,0,0,2128,2160,0,0
.long 2128,2160,0,0,2128,2160,0,0
.long 2128,2160,0,0,2128,2160,0,0
.long 2128,2160,0,0,2128,2160,0,0
.long 16256,0,0,0,1065353216,0,0,0
.long 0,16256,0,0,0,1065353216,0,0
.long 0,0,0,0,0,0,0,0
.long 0,0,0,0,0,0,0,0
.long 0,0,16256,0,0,0,1065353216,0
.long 0,0,0,16256,0,0,0,1065353216
.long 0,0,0,0,0,0,0,0
.long 0,0,0,0,0,0,0,0
.long 0,0,0,0,0,0,0,0
.long 0,0,0,0,0,0,0,0
.long 0,0,0,0,0,0,0,0
.long 0,0,0,0,0,0,0,0
.long 0,0,0,0,0,0,0,0
.long 0,0,0,0,0,0,0,0
.long 0,0,0,0,0,0,0,0
.long 0,0,0,0,0,0,0,0
.long 0,0,0,0,0,0,0,0
.long 0,0,0,0,0,0,0,0
.long 16256,0,0,0,1065353216,0,0,0
.long 0,16256,0,0,0,1065353216,0,0
.long 0,0,0,0,0,0,0,0
.long 0,0,0,0,0,0,0,0
.long 0,0,16256,0,0,0,1065353216,0
.long 0,0,0,16256,0,0,0,1065353216
.long 0,0,0,0,0,0,0,0
.long 0,0,0,0,0,0,0,0
.long 0,0,0,0,0,0,0,0
.long 0,0,0,0,0,0,0,0
.long 0,0,0,0,0,0,0,0
.long 0,0,0,0,0,0,0,0
.long 0,0,0,0,0,0,0,0
.long 0,0,0,0,0,0,0,0
.long 0,0,0,0,0,0,0,0
.long 0,0,0,0,0,0,0,0
.long 0,0,0,0,0,0,0,0
.long 0,0,0,0,0,0,0,0
.long 0,0,0,0,0,0,0,0
.long 0,0,0,0,0,0,0,0
.long 0,0,0,0,0,0,0,0
.long 0,0,0,0,0,0,0,0
.long 16256,0,0,0,1065353216,0,0,0
.long 0,16256,0,0,0,1065353216,0,0
.long 0,0,0,0,0,0,0,0
.long 0,0,0,0,0,0,0,0
.long 0,0,16256,0,0,0,1065353216,0
.long 0,0,0,16256,0,0,0,1065353216
.long 0,0,0,0,0,0,0,0
.long 0,0,0,0,0,0,0,0
.long 0,0,0,0,0,0,0,0
.long 0,0,0,0,0,0,0,0
.long 0,0,0,0,0,0,0,0
.long 0,0,0,0,0,0,0,0
.long 0,0,0,0,0,0,0,0
.long 0,0,0,0,0,0,0,0
.long 0,0,0,0,0,0,0,0
.long 0,0,0,0,0,0,0,0
.long 0,0,0,0,0,0,0,0
.long 0,0,0,0,0,0,0,0
.long 16256,0,0,0,1065353216,0,0,0
.long 0,16256,0,0,0,1065353216,0,0
.long 0,0,0,0,0,0,0,0
.long 0,0,0,0,0,0,0,0
.long 0,0,16256,0,0,0,1065353216,0
.long 0,0,0,16256,0,0,0,1065353216
.long 0,146432,134144,65600,16,146448,134160,65608
.long 32,146464,134176,65616,48,146480,134192,65624
.long 64,146496,134208,65728,80,146512,134224,65736
.long 96,146528,134240,65744,112,146544,134256,65752
.long 1024,146560,134272,65792,1040,146576,134288,65800
.long 1056,146592,134304,65808,1072,146608,134320,65816
.long 1088,146624,134336,65920,1104,146640,134352,65928
.long 1120,146656,134368,65936,1136,146672,134384,65944
.long 2112,146688,134400,65632,2128,146704,134416,65640
.long 2144,146720,134432,65648,2160,146736,134448,65656
.long 2048,146752,134464,65760,2064,146768,134480,65768
.long 2080,146784,134496,65776,2096,146800,134512,65784
.long 3136,146816,134528,65824,3152,146832,134544,65832
.long 3168,146848,134560,65840,3184,146864,134576,65848
.long 3072,146880,134592,65952,3088,146896,134608,65960
.long 3104,146912,134624,65968,3120,146928,134640,65976
.long 4096,146944,134656,66112,4112,146960,134672,66120
.long 4128,146976,134688,66128,4144,146992,134704,66136
.long 4160,147008,134720,66240,4176,147024,134736,66248
.long 4192,147040,134752,66256,4208,147056,134768,66264
.long 5120,147072,134784,66304,5136,147088,134800,66312
.long 5152,147104,134816,66320,5168,147120,134832,66328
.long 5184,147136,134848,66432,5200,147152,134864,66440
.long 5216,147168,134880,66448,5232,147184,134896,66456
.long 6208,147200,134912,66144,6224,147216,134928,66152
.long 6240,147232,134944,66160,6256,147248,134960,66168
.long 6144,147264,134976,66272,6160,147280,134992,66280
.long 6176,147296,135008,66288,6192,147312,135024,66296
.long 7232,147328,135040,66336,7248,147344,135056,66344
.long 7264,147360,135072,66352,7280,147376,135088,66360
.long 7168,147392,135104,66464,7184,147408,135120,66472
.long 7200,147424,135136,66480,7216,147440,135152,66488
.long 65536,73728,0,0,65544,73744,1024,4
.long 65552,73760,2048,8,65560,73776,3072,12
.long 65664,73792,4096,16,65672,73808,5120,20
.long 65680,73824,6144,24,65688,73840,7168,28
.long 65856,73856,8192,32,65864,73872,9216,36
.long 65872,73888,10240,40,65880,73904,11264,44
.long 65984,73920,12288,48,65992,73936,13312,52
.long 66000,73952,14336,56,66008,73968,15360,60
.long 65568,73984,16384,64,65576,74000,17408,68
.long 65584,74016,18432,72,65592,74032,19456,76
.long 65696,74048,20480,80,65704,74064,21504,84
.long 65712,74080,22528,88,65720,74096,23552,92
.long 65888,74112,24576,96,65896,74128,25600,100
.long 65904,74144,26624,104,65912,74160,27648,108
.long 66016,74176,28672,112,66024,74192,29696,116
.long 66032,74208,30720,120,66040,74224,31744,124
.long 66048,74240,16,0,66056,74256,1040,4
.long 66064,74272,2064,8,66072,74288,3088,12
.long 66176,74304,4112,16,66184,74320,5136,20
.long 66192,74336,6160,24,66200,74352,7184,28
.long 66368,74368,8208,32,66376,74384,9232,36
.long 66384,74400,10256,40,66392,74416,11280,44
.long 66496,74432,12304,48,66504,74448,13328,52
.long 66512,74464,14352,56,66520,74480,15376,60
.long 66080,74496,16400,64,66088,74512,17424,68
.long 66096,74528,18448,72,66104,74544,19472,76
.long 66208,74560,20496,80,66216,74576,21520,84
.long 66224,74592,22544,88,66232,74608,23568,92
.long 66400,74624,24592,96,66408,74640,25616,100
.long 66416,74656,26640,104,66424,74672,27664,108
.long 66528,74688,28688,112,66536,74704,29712,116
.long 66544,74720,30736,120,66552,74736,31760,124
.long 8192,8224,8256,8288,8320,8352,8384,8416
.long 8464,8496,8528,8560,8592,8624,8656,8688
.long 8736,8704,8800,8768,8864,8832,8928,8896
.long 9008,8976,9072,9040,9136,9104,9200,9168
.long 9280,9312,9216,9248,9408,9440,9344,9376
.long 9552,9584,9488,9520,9680,9712,9616,9648
.long 9824,9792,9760,9728,9952,9920,9888,9856
.long 10096,10064,10032,10000,10224,10192,10160,10128
.long 10240,10272,10304,10336,10368,10400,10432,10464
.long 10512,10544,10576,10608,10640,10672,10704,10736
.long 10784,10752,10848,10816,10912,10880,10976,10944
.long 11056,11024,11120,11088,11184,11152,11248,11216
.long 11328,11360,11264,11296,11456,11488,11392,11424
.long 11600,11632,11536,11568,11728,11760,11664,11696
.long 11872,11840,11808,11776,12000,11968,11936,11904
.long 12144,12112,12080,12048,12272,12240,12208,12176
.long 8208,8240,8272,8304,8336,8368,8400,8432
.long 8448,8480,8512,8544,8576,8608,8640,8672
.long 8752,8720,8816,8784,8880,8848,8944,8912
.long 8992,8960,9056,9024,9120,9088,9184,9152
.long 9296,9328,9232,9264,9424,9456,9360,9392
.long 9536,9568,9472,9504,9664,9696,9600,9632
.long 9840,9808,9776,9744,9968,9936,9904,9872
.long 10080,10048,10016,9984,10208,10176,10144,10112
.long 10256,10288,10320,10352,10384,10416,10448,10480
.long 10496,10528,10560,10592,10624,10656,10688,10720
.long 10800,10768,10864,10832,10928,10896,10992,10960
.long 11040,11008,11104,11072,11168,11136,11232,11200
.long 11344,11376,11280,11312,11472,11504,11408,11440
.long 11584,11616,11520,11552,11712,11744,11648,11680
.long 11888,11856,11824,11792,12016,11984,11952,11920
.long 12128,12096,12064,12032,12256,12224,12192,12160
.long 16448,81984,9216,131136,16456,81992,9224,131144
.long 16464,82000,9232,131152,16472,82008,9240,131160
.long 16576,82112,9248,131264,16584,82120,9256,131272
.long 16592,82128,9264,131280,16600,82136,9272,131288
.long 16640,82176,9280,131328,16648,82184,9288,131336
.long 16656,82192,9296,131344,16664,82200,9304,131352
.long 16768,82304,9312,131456,16776,82312,9320,131464
.long 16784,82320,9328,131472,16792,82328,9336,131480
.long 16480,82016,9216,131168,16488,82024,9224,131176
.long 16496,82032,9232,131184,16504,82040,9240,131192
.long 16608,82144,9248,131296,16616,82152,9256,131304
.long 16624,82160,9264,131312,16632,82168,9272,131320
.long 16672,82208,9280,131360,16680,82216,9288,131368
.long 16688,82224,9296,131376,16696,82232,9304,131384
.long 16800,82336,9312,131488,16808,82344,9320,131496
.long 16816,82352,9328,131504,16824,82360,9336,131512
.long 18496,84032,9344,132160,18504,84040,9352,132168
.long 18512,84048,9360,132176,18520,84056,9368,132184
.long 18624,84160,9376,132288,18632,84168,9384,132296
.long 18640,84176,9392,132304,18648,84184,9400,132312
.long 18688,84224,9408,132352,18696,84232,9416,132360
.long 18704,84240,9424,132368,18712,84248,9432,132376
.long 18816,84352,9440,132480,18824,84360,9448,132488
.long 18832,84368,9456,132496,18840,84376,9464,132504
.long 18528,84064,9344,132192,18536,84072,9352,132200
.long 18544,84080,9360,132208,18552,84088,9368,132216
.long 18656,84192,9376,132320,18664,84200,9384,132328
.long 18672,84208,9392,132336,18680,84216,9400,132344
.long 18720,84256,9408,132384,18728,84264,9416,132392
.long 18736,84272,9424,132400,18744,84280,9432,132408
.long 18848,84384,9440,132512,18856,84392,9448,132520
.long 18864,84400,9456,132528,18872,84408,9464,132536
.long 0,0,106496,77824,16,16,106512,77840
.long 32,32,106528,77856,48,48,106544,77872
.long 128,64,106560,77888,144,80,106576,77904
.long 160,96,106592,77920,176,112,106608,77936
.long 64,128,106624,77952,80,144,106640,77968
.long 96,160,106656,77984,112,176,106672,78000
.long 192,192,106688,78016,208,208,106704,78032
.long 224,224,106720,78048,240,240,106736,78064
.long 256,65536,106752,78080,272,65552,106768,78096
.long 288,65568,106784,78112,304,65584,106800,78128
.long 384,65600,106816,78144,400,65616,106832,78160
.long 416,65632,106848,78176,432,65648,106864,78192
.long 320,65664,106880,78208,336,65680,106896,78224
.long 352,65696,106912,78240,368,65712,106928,78256
.long 448,65728,106944,78272,464,65744,106960,78288
.long 480,65760,106976,78304,496,65776,106992,78320
.long 512,256,107008,78336,528,272,107024,78352
.long 544,288,107040,78368,560,304,107056,78384
.long 640,320,107072,78400,656,336,107088,78416
.long 672,352,107104,78432,688,368,107120,78448
.long 576,384,107136,78464,592,400,107152,78480
.long 608,416,107168,78496,624,432,107184,78512
.long 704,448,107200,78528,720,464,107216,78544
.long 736,480,107232,78560,752,496,107248,78576
.long 768,65792,107264,78592,784,65808,107280,78608
.long 800,65824,107296,78624,816,65840,107312,78640
.long 896,65856,107328,78656,912,65872,107344,78672
.long 928,65888,107360,78688,944,65904,107376,78704
.long 832,65920,107392,78720,848,65936,107408,78736
.long 864,65952,107424,78752,880,65968,107440,78768
.long 960,65984,107456,78784,976,66000,107472,78800
.long 992,66016,107488,78816,1008,66032,107504,78832
.long 2048,2080,0,0,2048,2080,0,0
.long 2048,2080,0,0,2048,2080,0,0
.long 2048,2080,0,0,2048,2080,0,0
.long 2048,2080,0,0,2048,2080,0,0
.long 2048,2080,0,0,2048,2080,0,0
.long 2048,2080,0,0,2048,2080,0,0
.long 2048,2080,0,0,2048,2080,0,0
.long 2048,2080,0,0,2048,2080,0,0
.long 0,512,1065369472,1065369472,16,528,0,0
.long 32,544,0,0,48,560,0,0
.long 64,576,1065369472,1065369472,80,592,0,0
.long 96,608,0,0,112,624,0,0
.long 128,640,0,0,144,656,0,0
.long 160,672,0,0,176,688,0,0
.long 192,704,0,0,208,720,0,0
.long 224,736,0,0,240,752,0,0
.long 2064,2096,0,0,2064,2096,0,0
.long 2064,2096,0,0,2064,2096,0,0
.long 2064,2096,0,0,2064,2096,0,0
.long 2064,2096,0,0,2064,2096,0,0
.long 2064,2096,0,0,2064,2096,0,0
.long 2064,2096,0,0,2064,2096,0,0
.long 2064,2096,0,0,2064,2096,0,0
.long 2064,2096,0,0,2064,2096,0,0
.long 256,768,1065369472,1065369472,272,784,0,0
.long 288,800,0,0,304,816,0,0
.long 320,832,1065369472,1065369472,336,848,0,0
.long 352,864,0,0,368,880,0,0
.long 384,896,0,0,400,912,0,0
.long 416,928,0,0,432,944,0,0
.long 448,960,0,0,464,976,0,0
.long 480,992,0,0,496,1008,0,0
.long 16256,0,0,0,1065353216,0,0,0
.long 0,16256,0,0,0,1065353216,0,0
.long 0,0,0,0,0,0,0,0
.long 0,0,0,0,0,0,0,0
.long 0,0,16256,0,0,0,1065353216,0
.long 0,0,0,16256,0,0,0,1065353216
.long 0,0,0,0,0,0,0,0
.long 0,0,0,0,0,0,0,0
.long 0,0,0,0,0,0,0,0
.long 0,0,0,0,0,0,0,0
.long 0,0,0,0,0,0,0,0
.long 0,0,0,0,0,0,0,0
.long 0,0,0,0,0,0,0,0
.long 0,0,0,0,0,0,0,0
.long 0,0,0,0,0,0,0,0
.long 0,0,0,0,0,0,0,0
.long 0,0,0,0,0,0,0,0
.long 0,0,0,0,0,0,0,0
.long 16256,0,0,0,1065353216,0,0,0
.long 0,16256,0,0,0,1065353216,0,0
.long 0,0,0,0,0,0,0,0
.long 0,0,0,0,0,0,0,0
.long 0,0,16256,0,0,0,1065353216,0
.long 0,0,0,16256,0,0,0,1065353216
.long 0,0,0,0,0,0,0,0
.long 0,0,0,0,0,0,0,0
.long 0,0,0,0,0,0,0,0
.long 0,0,0,0,0,0,0,0
.long 0,0,0,0,0,0,0,0
.long 0,0,0,0,0,0,0,0
.long 0,0,0,0,0,0,0,0
.long 0,0,0,0,0,0,0,0
.long 0,0,0,0,0,0,0,0
.long 0,0,0,0,0,0,0,0
.long 0,0,0,0,0,0,0,0
.long 0,0,0,0,0,0,0,0
.long 0,0,0,0,0,0,0,0
.long 0,0,0,0,0,0,0,0
.long 0,0,0,0,0,0,0,0
.long 0,0,0,0,0,0,0,0
.long 16256,0,0,0,1065353216,0,0,0
.long 0,16256,0,0,0,1065353216,0,0
.long 0,0,0,0,0,0,0,0
.long 0,0,0,0,0,0,0,0
.long 0,0,16256,0,0,0,1065353216,0
.long 0,0,0,16256,0,0,0,1065353216
.long 0,0,0,0,0,0,0,0
.long 0,0,0,0,0,0,0,0
.long 0,0,0,0,0,0,0,0
.long 0,0,0,0,0,0,0,0
.long 0,0,0,0,0,0,0,0
.long 0,0,0,0,0,0,0,0
.long 0,0,0,0,0,0,0,0
.long 0,0,0,0,0,0,0,0
.long 0,0,0,0,0,0,0,0
.long 0,0,0,0,0,0,0,0
.long 0,0,0,0,0,0,0,0
.long 0,0,0,0,0,0,0,0
.long 16256,0,0,0,1065353216,0,0,0
.long 0,16256,0,0,0,1065353216,0,0
.long 0,0,0,0,0,0,0,0
.long 0,0,0,0,0,0,0,0
.long 0,0,16256,0,0,0,1065353216,0
.long 0,0,0,16256,0,0,0,1065353216
.long 0,149504,137216,98400,16,149520,137232,98408
.long 32,149536,137248,98416,48,149552,137264,98424
.long 64,149568,137280,98528,80,149584,137296,98536
.long 96,149600,137312,98544,112,149616,137328,98552
.long 1024,149632,137344,98592,1040,149648,137360,98600
.long 1056,149664,137376,98608,1072,149680,137392,98616
.long 1088,149696,137408,98720,1104,149712,137424,98728
.long 1120,149728,137440,98736,1136,149744,137456,98744
.long 2112,149760,137472,98368,2128,149776,137488,98376
.long 2144,149792,137504,98384,2160,149808,137520,98392
.long 2048,149824,137536,98496,2064,149840,137552,98504
.long 2080,149856,137568,98512,2096,149872,137584,98520
.long 3136,149888,137600,98560,3152,149904,137616,98568
.long 3168,149920,137632,98576,3184,149936,137648,98584
.long 3072,149952,137664,98688,3088,149968,137680,98696
.long 3104,149984,137696,98704,3120,150000,137712,98712
.long 4096,150016,137728,98912,4112,150032,137744,98920
.long 4128,150048,137760,98928,4144,150064,137776,98936
.long 4160,150080,137792,99040,4176,150096,137808,99048
.long 4192,150112,137824,99056,4208,150128,137840,99064
.long 5120,150144,137856,99104,5136,150160,137872,99112
.long 5152,150176,137888,99120,5168,150192,137904,99128
.long 5184,150208,137920,99232,5200,150224,137936,99240
.long 5216,150240,137952,99248,5232,150256,137968,99256
.long 6208,150272,137984,98880,6224,150288,138000,98888
.long 6240,150304,138016,98896,6256,150320,138032,98904
.long 6144,150336,138048,99008,6160,150352,138064,99016
.long 6176,150368,138080,99024,6192,150384,138096,99032
.long 7232,150400,138112,99072,7248,150416,138128,99080
.long 7264,150432,138144,99088,7280,150448,138160,99096
.long 7168,150464,138176,99200,7184,150480,138192,99208
.long 7200,150496,138208,99216,7216,150512,138224,99224
.long 98336,98304,0,0,98344,98320,1024,4
.long 98352,98336,2048,8,98360,98352,3072,12
.long 98464,98368,4096,16,98472,98384,5120,20
.long 98480,98400,6144,24,98488,98416,7168,28
.long 98656,98432,8192,32,98664,98448,9216,36
.long 98672,98464,10240,40,98680,98480,11264,44
.long 98784,98496,12288,48,98792,98512,13312,52
.long 98800,98528,14336,56,98808,98544,15360,60
.long 98304,98560,16384,64,98312,98576,17408,68
.long 98320,98592,18432,72,98328,98608,19456,76
.long 98432,98624,20480,80,98440,98640,21504,84
.long 98448,98656,22528,88,98456,98672,23552,92
.long 98624,98688,24576,96,98632,98704,25600,100
.long 98640,98720,26624,104,98648,98736,27648,108
.long 98752,98752,28672,112,98760,98768,29696,116
.long 98768,98784,30720,120,98776,98800,31744,124
.long 98848,98816,16,0,98856,98832,1040,4
.long 98864,98848,2064,8,98872,98864,3088,12
.long 98976,98880,4112,16,98984,98896,5136,20
.long 98992,98912,6160,24,99000,98928,7184,28
.long 99168,98944,8208,32,99176,98960,9232,36
.long 99184,98976,10256,40,99192,98992,11280,44
.long 99296,99008,12304,48,99304,99024,13328,52
.long 99312,99040,14352,56,99320,99056,15376,60
.long 98816,99072,16400,64,98824,99088,17424,68
.long 98832,99104,18448,72,98840,99120,19472,76
.long 98944,99136,20496,80,98952,99152,21520,84
.long 98960,99168,22544,88,98968,99184,23568,92
.long 99136,99200,24592,96,99144,99216,25616,100
.long 99152,99232,26640,104,99160,99248,27664,108
.long 99264,99264,28688,112,99272,99280,29712,116
.long 99280,99296,30736,120,99288,99312,31760,124
.long 12288,12320,12352,12384,12416,12448,12480,12512
.long 12560,12592,12624,12656,12688,12720,12752,12784
.long 12832,12800,12896,12864,12960,12928,13024,12992
.long 13104,13072,13168,13136,13232,13200,13296,13264
.long 13376,13408,13312,13344,13504,13536,13440,13472
.long 13648,13680,13584,13616,13776,13808,13712,13744
.long 13920,13888,13856,13824,14048,14016,13984,13952
.long 14192,14160,14128,14096,14320,14288,14256,14224
.long 14336,14368,14400,14432,14464,14496,14528,14560
.long 14608,14640,14672,14704,14736,14768,14800,14832
.long 14880,14848,14944,14912,15008,14976,15072,15040
.long 15152,15120,15216,15184,15280,15248,15344,15312
.long 15424,15456,15360,15392,15552,15584,15488,15520
.long 15696,15728,15632,15664,15824,15856,15760,15792
.long 15968,15936,15904,15872,16096,16064,16032,16000
.long 16240,16208,16176,16144,16368,16336,16304,16272
.long 12304,12336,12368,12400,12432,12464,12496,12528
.long 12544,12576,12608,12640,12672,12704,12736,12768
.long 12848,12816,12912,12880,12976,12944,13040,13008
.long 13088,13056,13152,13120,13216,13184,13280,13248
.long 13392,13424,13328,13360,13520,13552,13456,13488
.long 13632,13664,13568,13600,13760,13792,13696,13728
.long 13936,13904,13872,13840,14064,14032,14000,13968
.long 14176,14144,14112,14080,14304,14272,14240,14208
.long 14352,14384,14416,14448,14480,14512,14544,14576
.long 14592,14624,14656,14688,14720,14752,14784,14816
.long 14896,14864,14960,14928,15024,14992,15088,15056
.long 15136,15104,15200,15168,15264,15232,15328,15296
.long 15440,15472,15376,15408,15568,15600,15504,15536
.long 15680,15712,15616,15648,15808,15840,15744,15776
.long 15984,15952,15920,15888,16112,16080,16048,16016
.long 16224,16192,16160,16128,16352,16320,16288,16256
.long 16448,81984,9216,131136,16456,81992,9224,131144
.long 16464,82000,9232,131152,16472,82008,9240,131160
.long 16576,82112,9248,131264,16584,82120,9256,131272
.long 16592,82128,9264,131280,16600,82136,9272,131288
.long 16640,82176,9280,131328,16648,82184,9288,131336
.long 16656,82192,9296,131344,16664,82200,9304,131352
.long 16768,82304,9312,131456,16776,82312,9320,131464
.long 16784,82320,9328,131472,16792,82328,9336,131480
.long 16480,82016,9216,131168,16488,82024,9224,131176
.long 16496,82032,9232,131184,16504,82040,9240,131192
.long 16608,82144,9248,131296,16616,82152,9256,131304
.long 16624,82160,9264,131312,16632,82168,9272,131320
.long 16672,82208,9280,131360,16680,82216,9288,131368
.long 16688,82224,9296,131376,16696,82232,9304,131384
.long 16800,82336,9312,131488,16808,82344,9320,131496
.long 16816,82352,9328,131504,16824,82360,9336,131512
.long 18496,84032,9344,132160,18504,84040,9352,132168
.long 18512,84048,9360,132176,18520,84056,9368,132184
.long 18624,84160,9376,132288,18632,84168,9384,132296
.long 18640,84176,9392,132304,18648,84184,9400,132312
.long 18688,84224,9408,132352,18696,84232,9416,132360
.long 18704,84240,9424,132368,18712,84248,9432,132376
.long 18816,84352,9440,132480,18824,84360,9448,132488
.long 18832,84368,9456,132496,18840,84376,9464,132504
.long 18528,84064,9344,132192,18536,84072,9352,132200
.long 18544,84080,9360,132208,18552,84088,9368,132216
.long 18656,84192,9376,132320,18664,84200,9384,132328
.long 18672,84208,9392,132336,18680,84216,9400,132344
.long 18720,84256,9408,132384,18728,84264,9416,132392
.long 18736,84272,9424,132400,18744,84280,9432,132408
.long 18848,84384,9440,132512,18856,84392,9448,132520
.long 18864,84400,9456,132528,18872,84408,9464,132536
.long 0,0,114688,79872,16,16,114704,79888
.long 32,32,114720,79904,48,48,114736,79920
.long 128,64,114752,79936,144,80,114768,79952
.long 160,96,114784,79968,176,112,114800,79984
.long 64,128,114816,80000,80,144,114832,80016
.long 96,160,114848,80032,112,176,114864,80048
.long 192,192,114880,80064,208,208,114896,80080
.long 224,224,114912,80096,240,240,114928,80112
.long 256,65536,114944,80128,272,65552,114960,80144
.long 288,65568,114976,80160,304,65584,114992,80176
.long 384,65600,115008,80192,400,65616,115024,80208
.long 416,65632,115040,80224,432,65648,115056,80240
.long 320,65664,115072,80256,336,65680,115088,80272
.long 352,65696,115104,80288,368,65712,115120,80304
.long 448,65728,115136,80320,464,65744,115152,80336
.long 480,65760,115168,80352,496,65776,115184,80368
.long 512,256,115200,80384,528,272,115216,80400
.long 544,288,115232,80416,560,304,115248,80432
.long 640,320,115264,80448,656,336,115280,80464
.long 672,352,115296,80480,688,368,115312,80496
.long 576,384,115328,80512,592,400,115344,80528
.long 608,416,115360,80544,624,432,115376,80560
.long 704,448,115392,80576,720,464,115408,80592
.long 736,480,115424,80608,752,496,115440,80624
.long 768,65792,115456,80640,784,65808,115472,80656
.long 800,65824,115488,80672,816,65840,115504,80688
.long 896,65856,115520,80704,912,65872,115536,80720
.long 928,65888,115552,80736,944,65904,115568,80752
.long 832,65920,115584,80768,848,65936,115600,80784
.long 864,65952,115616,80800,880,65968,115632,80816
.long 960,65984,115648,80832,976,66000,115664,80848
.long 992,66016,115680,80864,1008,66032,115696,80880
.long 2112,2144,0,0,2112,2144,0,0
.long 2112,2144,0,0,2112,2144,0,0
.long 2112,2144,0,0,2112,2144,0,0
.long 2112,2144,0,0,2112,2144,0,0
.long 2112,2144,0,0,2112,2144,0,0
.long 2112,2144,0,0,2112,2144,0,0
.long 2112,2144,0,0,2112,2144,0,0
.long 2112,2144,0,0,2112,2144,0,0
.long 1024,1536,1065369472,1065369472,1040,1552,0,0
.long 1056,1568,0,0,1072,1584,0,0
.long 1088,1600,1065369472,1065369472,1104,1616,0,0
.long 1120,1632,0,0,1136,1648,0,0
.long 1152,1664,0,0,1168,1680,0,0
.long 1184,1696,0,0,1200,1712,0,0
.long 1216,1728,0,0,1232,1744,0,0
.long 1248,1760,0,0,1264,1776,0,0
.long 2128,2160,0,0,2128,2160,0,0
.long 2128,2160,0,0,2128,2160,0,0
.long 2128,2160,0,0,2128,2160,0,0
.long 2128,2160,0,0,2128,2160,0,0
.long 2128,2160,0,0,2128,2160,0,0
.long 2128,2160,0,0,2128,2160,0,0
.long 2128,2160,0,0,2128,2160,0,0
.long 2128,2160,0,0,2128,2160,0,0
.long 1280,1792,1065369472,1065369472,1296,1808,0,0
.long 1312,1824,0,0,1328,1840,0,0
.long 1344,1856,1065369472,1065369472,1360,1872,0,0
.long 1376,1888,0,0,1392,1904,0,0
.long 1408,1920,0,0,1424,1936,0,0
.long 1440,1952,0,0,1456,1968,0,0
.long 1472,1984,0,0,1488,2000,0,0
.long 1504,2016,0,0,1520,2032,0,0
.long 16256,0,0,0,1065353216,0,0,0
.long 0,16256,0,0,0,1065353216,0,0
.long 0,0,0,0,0,0,0,0
.long 0,0,0,0,0,0,0,0
.long 0,0,16256,0,0,0,1065353216,0
.long 0,0,0,16256,0,0,0,1065353216
.long 0,0,0,0,0,0,0,0
.long 0,0,0,0,0,0,0,0
.long 0,0,0,0,0,0,0,0
.long 0,0,0,0,0,0,0,0
.long 0,0,0,0,0,0,0,0
.long 0,0,0,0,0,0,0,0
.long 0,0,0,0,0,0,0,0
.long 0,0,0,0,0,0,0,0
.long 0,0,0,0,0,0,0,0
.long 0,0,0,0,0,0,0,0
.long 0,0,0,0,0,0,0,0
.long 0,0,0,0,0,0,0,0
.long 16256,0,0,0,1065353216,0,0,0
.long 0,16256,0,0,0,1065353216,0,0
.long 0,0,0,0,0,0,0,0
.long 0,0,0,0,0,0,0,0
.long 0,0,16256,0,0,0,1065353216,0
.long 0,0,0,16256,0,0,0,1065353216
.long 0,0,0,0,0,0,0,0
.long 0,0,0,0,0,0,0,0
.long 0,0,0,0,0,0,0,0
.long 0,0,0,0,0,0,0,0
.long 0,0,0,0,0,0,0,0
.long 0,0,0,0,0,0,0,0
.long 0,0,0,0,0,0,0,0
.long 0,0,0,0,0,0,0,0
.long 0,0,0,0,0,0,0,0
.long 0,0,0,0,0,0,0,0
.long 0,0,0,0,0,0,0,0
.long 0,0,0,0,0,0,0,0
.long 0,0,0,0,0,0,0,0
.long 0,0,0,0,0,0,0,0
.long 0,0,0,0,0,0,0,0
.long 0,0,0,0,0,0,0,0
.long 16256,0,0,0,1065353216,0,0,0
.long 0,16256,0,0,0,1065353216,0,0
.long 0,0,0,0,0,0,0,0
.long 0,0,0,0,0,0,0,0
.long 0,0,16256,0,0,0,1065353216,0
.long 0,0,0,16256,0,0,0,1065353216
.long 0,0,0,0,0,0,0,0
.long 0,0,0,0,0,0,0,0
.long 0,0,0,0,0,0,0,0
.long 0,0,0,0,0,0,0,0
.long 0,0,0,0,0,0,0,0
.long 0,0,0,0,0,0,0,0
.long 0,0,0,0,0,0,0,0
.long 0,0,0,0,0,0,0,0
.long 0,0,0,0,0,0,0,0
.long 0,0,0,0,0,0,0,0
.long 0,0,0,0,0,0,0,0
.long 0,0,0,0,0,0,0,0
.long 16256,0,0,0,1065353216,0,0,0
.long 0,16256,0,0,0,1065353216,0,0
.long 0,0,0,0,0,0,0,0
.long 0,0,0,0,0,0,0,0
.long 0,0,16256,0,0,0,1065353216,0
.long 0,0,0,16256,0,0,0,1065353216
.long 0,152576,140288,98400,16,152592,140304,98408
.long 32,152608,140320,98416,48,152624,140336,98424
.long 64,152640,140352,98528,80,152656,140368,98536
.long 96,152672,140384,98544,112,152688,140400,98552
.long 1024,152704,140416,98592,1040,152720,140432,98600
.long 1056,152736,140448,98608,1072,152752,140464,98616
.long 1088,152768,140480,98720,1104,152784,140496,98728
.long 1120,152800,140512,98736,1136,152816,140528,98744
.long 2112,152832,140544,98368,2128,152848,140560,98376
.long 2144,152864,140576,98384,2160,152880,140592,98392
.long 2048,152896,140608,98496,2064,152912,140624,98504
.long 2080,152928,140640,98512,2096,152944,140656,98520
.long 3136,152960,140672,98560,3152,152976,140688,98568
.long 3168,152992,140704,98576,3184,153008,140720,98584
.long 3072,153024,140736,98688,3088,153040,140752,98696
.long 3104,153056,140768,98704,3120,153072,140784,98712
.long 4096,153088,140800,98912,4112,153104,140816,98920
.long 4128,153120,140832,98928,4144,153136,140848,98936
.long 4160,153152,140864,99040,4176,153168,140880,99048
.long 4192,153184,140896,99056,4208,153200,140912,99064
.long 5120,153216,140928,99104,5136,153232,140944,99112
.long 5152,153248,140960,99120,5168,153264,140976,99128
.long 5184,153280,140992,99232,5200,153296,141008,99240
.long 5216,153312,141024,99248,5232,153328,141040,99256
.long 6208,153344,141056,98880,6224,153360,141072,98888
.long 6240,153376,141088,98896,6256,153392,141104,98904
.long 6144,153408,141120,99008,6160,153424,141136,99016
.long 6176,153440,141152,99024,6192,153456,141168,99032
.long 7232,153472,141184,99072,7248,153488,141200,99080
.long 7264,153504,141216,99088,7280,153520,141232,99096
.long 7168,153536,141248,99200,7184,153552,141264,99208
.long 7200,153568,141280,99216,7216,153584,141296,99224
.long 98336,106496,0,0,98344,106512,1024,4
.long 98352,106528,2048,8,98360,106544,3072,12
.long 98464,106560,4096,16,98472,106576,5120,20
.long 98480,106592,6144,24,98488,106608,7168,28
.long 98656,106624,8192,32,98664,106640,9216,36
.long 98672,106656,10240,40,98680,106672,11264,44
.long 98784,106688,12288,48,98792,106704,13312,52
.long 98800,106720,14336,56,98808,106736,15360,60
.long 98304,106752,16384,64,98312,106768,17408,68
.long 98320,106784,18432,72,98328,106800,19456,76
.long 98432,106816,20480,80,98440,106832,21504,84
.long 98448,106848,22528,88,98456,106864,23552,92
.long 98624,106880,24576,96,98632,106896,25600,100
.long 98640,106912,26624,104,98648,106928,27648,108
.long 98752,106944,28672,112,98760,106960,29696,116
.long 98768,106976,30720,120,98776,106992,31744,124
.long 98848,107008,16,0,98856,107024,1040,4
.long 98864,107040,2064,8,98872,107056,3088,12
.long 98976,107072,4112,16,98984,107088,5136,20
.long 98992,107104,6160,24,99000,107120,7184,28
.long 99168,107136,8208,32,99176,107152,9232,36
.long 99184,107168,10256,40,99192,107184,11280,44
.long 99296,107200,12304,48,99304,107216,13328,52
.long 99312,107232,14352,56,99320,107248,15376,60
.long 98816,107264,16400,64,98824,107280,17424,68
.long 98832,107296,18448,72,98840,107312,19472,76
.long 98944,107328,20496,80,98952,107344,21520,84
.long 98960,107360,22544,88,98968,107376,23568,92
.long 99136,107392,24592,96,99144,107408,25616,100
.long 99152,107424,26640,104,99160,107440,27664,108
.long 99264,107456,28688,112,99272,107472,29712,116
.long 99280,107488,30736,120,99288,107504,31760,124
.set b, 0
.rept 256
.set w, 0
.rept 8
.long (65536+(((((((b&3)<<1)+((b>>4)&1))<<5)+(((((b>>2)&1)<<3)+(b>>5))<<1))+((b>>3)&1))<<7))
.long (65536+((b&7)<<12))
.long (131072+((((((b&3)<<1)+((b>>4)&1))<<4)+((((b>>2)&1)<<3)+(b>>5)))<<7))
.long (131072+((b&7)<<11))
.long ((6291456+((((((b&3)<<1)+((b>>4)&1))<<2)+((w>>2)<<1))<<16))+(((((((b>>2)&1)<<3)+(b>>5))<<2)+(w&3))<<10))
.long (((2097152+(((b>>3)&1)*2097152))+((((((b&3)<<1)+((b>>4)&1))<<2)+((w>>2)<<1))<<16))+(((((((b>>2)&1)<<3)+(b>>5))<<2)+(w&3))<<10))
.long (((w>>2)<<15)+((w&3)<<10))
.long ((4194304+((((b&7)<<2)+((b>>3)&3))<<16))+(((w>>2)<<15)+((w&3)<<10)))
.long (4194304+((((b&7)<<2)+((b>>3)&3))<<16))
.long ((2097152+((((b&7)<<2)+((b>>3)&3))<<16))+(((((b>>5)<<3)+((w&3)<<1))+(w>>2))<<10))
.long ((2097152+((((b&7)<<2)+((b>>3)&3))<<16))+((((((b>>5)<<3)+((w&3)<<1))+(w>>2))^1)<<10))
.long (((1-((b>>3)&1))*((33+((((w-1)>>8)&1)*2))+(((((w-3)>>8)&1)-(((w-1)>>8)&1))*4)))+(((b>>3)&1)*(40+((((w-1)>>8)&1)*16))))
.long (8388608+((((((((((b&3)<<1)+((b>>4)&1))<<2)+((w>>2)<<1))^16)+((w&3)>>1))<<4)+((((b>>2)&1)<<3)+(b>>5)))<<12))
.long ((10518528+(((((b>>5)<<3)+((w&3)<<1))+(w>>2))<<16))+((((b&7)<<2)+((b>>3)&3))<<10))
.long ((10485760+((((((b>>5)<<2)+((b&7)>>1))<<1)+(w&1))<<16))+((w>>1)<<13))
.long ((10489856+((((((b>>5)<<2)+((b&7)>>1))<<1)+(w&1))<<16))+((w>>1)<<13))
.long ((((((((b>>5)<<2)+((b&7)>>1))<<1)+(w&1))<<15)+((((b&1)<<2)+((b>>3)&3))<<7))+((w>>1)<<5))
.long (((((w>>2)<<4)+(w&3))<<13)+((((b&1)<<2)+((b>>3)&3))<<7))
.long (327680+((b>>5)<<11))
.long (327680+(((((((b>>2)&1)<<3)+(b>>5))<<3)+(((b&3)<<1)+((b>>4)&1)))<<7))
.long (4294967295-((((((b&7)^(((b&3)<<1)+((b>>4)&1)))-1)>>8)&1)<<((((((b>>2)&1)<<3)+(b>>5))<<1)+((b>>3)&1))))
.long (262144+((((((b>>5)<<2)+((b&7)>>1))<<1)+(w&1))<<7))
.long (262144+(((((b>>5)<<3)+((w&3)<<1))+(w>>2))<<7))
.long ((((((((b>>2)&1)<<3)+(b>>5))<<7)+((((b&3)<<1)+((b>>4)&1))<<4))+(w<<1))<<10)
.long (262144+((((((((b>>2)&1)<<3)+(b>>5))<<7)+((((b&3)<<1)+((b>>4)&1))<<4))+(w<<1))<<2))
.long ((((((b&3)<<1)+((b>>4)&1))^4)<<11)+((w&1)<<10))
.long ((8388608+((((((((b&7)<<2)+((b>>3)&3))+w)-1)&31)^16)<<16))+((b>>5)<<8))
.long ((((458752+((((((((b&7)<<2)+((b>>3)&3))+w)-1)&31)^16)<<11))+(((b>>5)>>2)*544))+(((b>>5)&1)*272))+(((b>>5)&2)<<2))
.long ((393216+((((((((b&7)<<2)+((b>>3)&3))+w)-1)&31)^16)<<10))+((b>>5)<<7))
.long (393216+(((((((b&3)<<1)+((b>>4)&1))<<2)+((w>>2)<<1))^16)<<10))
.long (458752+(((((((b&3)<<1)+((b>>4)&1))<<2)+((w>>2)<<1))^16)<<11))
.long ((10485760+(((((((b>>2)&1)<<3)+(b>>5))<<2)+(w&3))<<16))+(((((((b&3)<<1)+((b>>4)&1))<<2)+((w>>2)<<1))^16)<<10))
.set w, w+1
.endr
.set b, b+1
.endr
```
